```python
import torch

def _softmax(x, axis=-1):
    return torch.softmax(x, dim=axis)
def _gelu(x):
    return torch.nn.functional.gelu(x, approximate="tanh")
def _silu(x):
    return torch.nn.functional.silu(x)
def _sigmoid(x):
    return torch.sigmoid(x)
def _layernorm(x, axis=-1, eps=1e-5):
    m = x.mean(dim=axis, keepdim=True)
    v = x.var(dim=axis, keepdim=True, unbiased=False)
    return (x - m) / torch.sqrt(v + eps)
def _scatter_add(tgt, idx, src, axis=0):
    return tgt.clone().index_add_(axis, idx, src)
def _segment_sum(src, seg, n):
    out = torch.zeros((n,) + src.shape[1:], dtype=src.dtype)
    return out.index_add_(0, seg, src)
def _pad(x, pw):
    flat = tuple(v for pair in reversed(pw) for v in pair)
    return torch.nn.functional.pad(x, flat)

kernel_name = 'gated_mix__linear_attn_block__glu_gated_glu__prompt'

def setup_inputs():

    _w = (lambda a: (lambda t: t.to(torch.bfloat16) if t.is_floating_point() else t)(torch.as_tensor(a)))
    def _A_setup():
        B, S, D = 1, 2048, 640
        return {
            "x": _w((lambda *s: torch.randn(*s, dtype=torch.bfloat16) * 0.05)(B, S, D)),
            "wqkv": _w((lambda *s: torch.randn(*s, dtype=torch.bfloat16) * 0.8)(D, 3 * D)),
            "wo": _w((lambda *s: torch.randn(*s, dtype=torch.bfloat16) * 0.2)(D, D)),
        }
    _A_in = _A_setup()

    def _B_setup():
        B, S, D, F = 1, 2048, 640, 1728
        return {
            "x": _w((lambda *s: torch.randn(*s, dtype=torch.bfloat16) * 0.05)(B, S, D)),
            "w_gate": _w((lambda *s: torch.randn(*s, dtype=torch.bfloat16) * 0.4)(D, F)),
            "w_up": _w((lambda *s: torch.randn(*s, dtype=torch.bfloat16) * 0.05)(D, F)),
            "w_down": _w((lambda *s: torch.randn(*s, dtype=torch.bfloat16) * 0.05)(F, D)),
        }
    _B_in = _B_setup()

    return {
        "A_x": _A_in["x"],
        "A_wqkv": _A_in["wqkv"],
        "A_wo": _A_in["wo"],
        "B_x": _B_in["x"],
        "B_w_gate": _B_in["w_gate"],
        "B_w_up": _B_in["w_up"],
        "B_w_down": _B_in["w_down"],
        "gate_w": _w((lambda *s: torch.randn(*s, dtype=torch.bfloat16) * 0.05)(640) * 16.0),
    }

def reference(A_x, A_wqkv, A_wo, B_x, B_w_gate, B_w_up, B_w_down, gate_w):
    def _A_ref(x, wqkv, wo):
        B, S, D = x.shape
        H = 32; Dh = D // H
        qkv = (lambda x, *d: x.permute(*d))((x @ wqkv).reshape(B, S, 3, H, Dh), 2, 0, 3, 1, 4)
        q, k, v = qkv[0], qkv[1], qkv[2]
        phi = lambda t: torch.where(t > 0, t + 1, torch.exp(t)) + 1e-6
        pq, pk = phi(q), phi(k)
        kv = torch.einsum("bhsd,bhse->bhde", pk, v)
        z = torch.einsum("bhsd->bhd", pk)
        num = torch.einsum("bhqd,bhde->bhqe", pq, kv)
        den = torch.einsum("bhqd,bhd->bhq", pq, z)[..., None] + 1e-6
        o = num / den
        return (lambda x, *d: x.permute(*d))(o, 0, 2, 1, 3).reshape(B, S, D) @ wo

    def _B_ref(x, w_gate, w_up, w_down):
        g = torch.einsum("bsd,df->bsf", x, w_gate)
        u = torch.einsum("bsd,df->bsf", x, w_up)
        h = _sigmoid(g) * u
        return torch.einsum("bsf,fd->bsd", h, w_down)

    x = A_x
    g = _sigmoid((x * gate_w).sum(-1, keepdims=True))
    a = _A_ref(x, A_wqkv, A_wo)
    b = _B_ref(x, B_w_gate, B_w_up, B_w_down)
    return g * a + (1 - g) * b
```

```asm
; @launch kernel=k1_kernel grid=(256,1,1) block=(512,1,1) lds=149504
; @launch kernel=k2_kernel grid=(256,1,1) block=(512,1,1) lds=160000
.amdgcn_target "amdgcn-amd-amdhsa--gfx950"
.text
.globl k1_kernel
.p2align 8
.type k1_kernel,@function
k1_kernel:
    s_cmp_ge_u32 s2, 256
    s_cbranch_scc1 K1_END
    s_load_dwordx16 s[4:19], s[0:1], 0
    s_load_dwordx4 s[20:23], s[0:1], 64
    s_load_dwordx2 s[24:25], s[0:1], 80
    v_lshrrev_b32 v2, 6, v0
    v_and_b32 v1, 63, v0
    v_readfirstlane_b32 s26, v2
    s_and_b32 s40, s2, 7
    s_lshr_b32 s41, s2, 3
    s_and_b32 s42, s40, 1
    s_lshl_b32 s42, s42, 3
    s_and_b32 s43, s41, 7
    s_add_u32 s42, s42, s43
    s_lshr_b32 s43, s40, 1
    s_lshl_b32 s43, s43, 2
    s_lshr_b32 s44, s41, 3
    s_add_u32 s43, s43, s44
    s_cmp_eq_u32 s43, 15
    s_cbranch_scc1 K1_PREP
    s_cmp_lt_u32 s26, 4
    s_cbranch_scc1 K1_COMPUTE
    s_sub_u32 s27, s26, 4
    s_lshr_b32 s44, s27, 1
    s_lshl_b32 s47, s27, 5
    v_lshrrev_b32 v2, 3, v1
    v_add_u32 v2, s47, v2
    v_mul_u32_u24 v2, 1280, v2
    v_lshrrev_b32 v3, 4, v1
    v_and_b32 v5, 7, v1
    v_xor_b32 v3, v3, v5
    v_lshlrev_b32 v3, 4, v3
    v_add_u32 v16, v2, v3
    v_xor_b32 v3, 64, v3
    v_add_u32 v17, v2, v3
    v_add_u32 v17, 10240, v17
    v_add_u32 v18, 20480, v16
    v_add_u32 v19, 20480, v17
    s_movk_i32 s45, 3456
    s_mul_i32 s46, s43, 384
    s_cmp_lt_u32 s43, 9
    s_cbranch_scc1 K1_LD_GO
    s_movk_i32 s45, 3840
    s_sub_u32 s46, s43, 9
    s_mul_i32 s46, s46, 320
    s_mul_i32 s47, s44, 1280
    s_add_u32 s46, s46, s47
    s_add_u32 s46, s46, 1280
    s_sub_u32 s47, s43, 13
    s_lshl_b32 s47, s47, 1
    s_add_u32 s47, s47, s44
    s_mul_i32 s47, s47, 320
    s_cmp_lt_u32 s43, 13
    s_cselect_b32 s46, s46, s47
    s_and_b32 s46, s46, 0xffffff80
K1_LD_GO:
    s_and_b32 s47, s27, 1
    s_mul_i32 s47, s47, 384
    s_mov_b32 s64, 2731
    s_lshl_b32 s63, s45, 3
    v_add_u32 v2, s47, v1
    v_mul_u32_u24 v3, s64, v2
    v_lshrrev_b32 v3, 16, v3
    v_mul_u32_u24 v5, 24, v3
    v_sub_u32 v5, v2, v5
    v_bfe_u32 v6, v3, 1, 1
    v_lshrrev_b32 v7, 2, v3
    v_and_or_b32 v6, v7, 2, v6
    v_lshrrev_b32 v7, 1, v5
    v_xor_b32 v7, v7, v6
    v_lshlrev_b32 v7, 5, v7
    v_and_b32 v5, 1, v5
    v_lshl_add_u32 v7, v5, 4, v7
    v_mul_lo_u32 v3, v3, s45
    v_add_u32 v10, v3, v7
    v_xor_b32 v7, 64, v7
    v_add3_u32 v13, v3, v7, s63
    v_add_u32 v2, s47, v1
    v_add_u32 v2, 64, v2
    v_mul_u32_u24 v3, s64, v2
    v_lshrrev_b32 v3, 16, v3
    v_mul_u32_u24 v5, 24, v3
    v_sub_u32 v5, v2, v5
    v_bfe_u32 v6, v3, 1, 1
    v_lshrrev_b32 v7, 2, v3
    v_and_or_b32 v6, v7, 2, v6
    v_lshrrev_b32 v7, 1, v5
    v_xor_b32 v7, v7, v6
    v_lshlrev_b32 v7, 5, v7
    v_and_b32 v5, 1, v5
    v_lshl_add_u32 v7, v5, 4, v7
    v_mul_lo_u32 v3, v3, s45
    v_add_u32 v11, v3, v7
    v_xor_b32 v7, 64, v7
    v_add3_u32 v14, v3, v7, s63
    v_add_u32 v2, s47, v1
    v_add_u32 v2, 128, v2
    v_mul_u32_u24 v3, s64, v2
    v_lshrrev_b32 v3, 16, v3
    v_mul_u32_u24 v5, 24, v3
    v_sub_u32 v5, v2, v5
    v_bfe_u32 v6, v3, 1, 1
    v_lshrrev_b32 v7, 2, v3
    v_and_or_b32 v6, v7, 2, v6
    v_lshrrev_b32 v7, 1, v5
    v_xor_b32 v7, v7, v6
    v_lshlrev_b32 v7, 5, v7
    v_and_b32 v5, 1, v5
    v_lshl_add_u32 v7, v5, 4, v7
    v_mul_lo_u32 v3, v3, s45
    v_add_u32 v12, v3, v7
    v_xor_b32 v7, 64, v7
    v_add3_u32 v15, v3, v7, s63
    s_mul_i32 s65, s42, 163840
    s_lshl_b32 s66, s45, 5
    s_mul_i32 s67, s27, 6144
    s_lshl_b32 s68, s27, 12
    s_add_u32 s68, s68, 98304
    s_waitcnt lgkmcnt(0)
    s_mov_b32 s28, s4
    s_mov_b32 s29, s5
    s_mov_b32 s30, 0x280000
    s_mov_b32 s31, 0x00020000
    s_mov_b32 s36, s24
    s_mov_b32 s37, s25
    s_mov_b32 s38, 0x10000000
    s_mov_b32 s39, 0x00020000
    s_mov_b32 s48, s18
    s_mov_b32 s49, s19
    s_mov_b32 s50, 0x500
    s_mov_b32 s51, 0x00020000
    s_mov_b32 s52, s22
    s_mov_b32 s53, s23
    s_mov_b32 s54, 0x100
    s_mov_b32 s55, 0x00020000
    s_mov_b32 s32, s6
    s_mov_b32 s33, s7
    s_mov_b32 s34, 0x258000
    s_mov_b32 s35, 0x00020000
    s_cmp_lt_u32 s43, 9
    s_cbranch_scc0 K1_LD_GO2
    s_cmp_eq_u32 s44, 0
    s_cselect_b32 s32, s12, s14
    s_cselect_b32 s33, s13, s15
    s_mov_b32 s34, 0x21c000
K1_LD_GO2:
    s_cmp_lt_u32 s43, 13
    s_cbranch_scc1 K1_LD_NGW
    v_lshlrev_b32 v2, 4, v1
    s_mov_b32 m0, 147456
    v_add_u32 v3, 1024, v2
    buffer_load_dwordx4 v2, s[48:51], 0 offen lds
    s_mov_b32 m0, 148480
    s_nop 0
    buffer_load_dwordx4 v3, s[48:51], 0 offen lds
K1_LD_NGW:
    s_mul_i32 s69, s66, 0
    s_add_u32 s69, s69, s46
    s_add_u32 m0, s67, 0
    s_nop 0
    buffer_load_dwordx4 v10, s[32:35], s69 offen lds
    s_add_u32 m0, s67, 1024
    s_nop 0
    buffer_load_dwordx4 v11, s[32:35], s69 offen lds
    s_add_u32 m0, s67, 2048
    s_nop 0
    buffer_load_dwordx4 v12, s[32:35], s69 offen lds
    s_add_u32 m0, s67, 3072
    s_nop 0
    buffer_load_dwordx4 v13, s[32:35], s69 offen lds
    s_add_u32 m0, s67, 4096
    s_nop 0
    buffer_load_dwordx4 v14, s[32:35], s69 offen lds
    s_add_u32 m0, s67, 5120
    s_nop 0
    buffer_load_dwordx4 v15, s[32:35], s69 offen lds
    s_add_u32 s70, s65, 0
    s_add_u32 m0, s68, 0
    s_nop 0
    buffer_load_dwordx4 v16, s[28:31], s70 offen lds
    s_add_u32 m0, s68, 1024
    s_nop 0
    buffer_load_dwordx4 v17, s[28:31], s70 offen lds
    s_add_u32 m0, s68, 2048
    s_nop 0
    buffer_load_dwordx4 v18, s[28:31], s70 offen lds
    s_add_u32 m0, s68, 3072
    s_nop 0
    buffer_load_dwordx4 v19, s[28:31], s70 offen lds
    s_mul_i32 s69, s66, 1
    s_add_u32 s69, s69, s46
    s_add_u32 m0, s67, 24576
    s_nop 0
    buffer_load_dwordx4 v10, s[32:35], s69 offen lds
    s_add_u32 m0, s67, 25600
    s_nop 0
    buffer_load_dwordx4 v11, s[32:35], s69 offen lds
    s_add_u32 m0, s67, 26624
    s_nop 0
    buffer_load_dwordx4 v12, s[32:35], s69 offen lds
    s_add_u32 m0, s67, 27648
    s_nop 0
    buffer_load_dwordx4 v13, s[32:35], s69 offen lds
    s_add_u32 m0, s67, 28672
    s_nop 0
    buffer_load_dwordx4 v14, s[32:35], s69 offen lds
    s_add_u32 m0, s67, 29696
    s_nop 0
    buffer_load_dwordx4 v15, s[32:35], s69 offen lds
    s_add_u32 s70, s65, 128
    s_add_u32 m0, s68, 16384
    s_nop 0
    buffer_load_dwordx4 v16, s[28:31], s70 offen lds
    s_add_u32 m0, s68, 17408
    s_nop 0
    buffer_load_dwordx4 v17, s[28:31], s70 offen lds
    s_add_u32 m0, s68, 18432
    s_nop 0
    buffer_load_dwordx4 v18, s[28:31], s70 offen lds
    s_add_u32 m0, s68, 19456
    s_nop 0
    buffer_load_dwordx4 v19, s[28:31], s70 offen lds
    s_mul_i32 s69, s66, 2
    s_add_u32 s69, s69, s46
    s_add_u32 m0, s67, 49152
    s_nop 0
    buffer_load_dwordx4 v10, s[32:35], s69 offen lds
    s_add_u32 m0, s67, 50176
    s_nop 0
    buffer_load_dwordx4 v11, s[32:35], s69 offen lds
    s_add_u32 m0, s67, 51200
    s_nop 0
    buffer_load_dwordx4 v12, s[32:35], s69 offen lds
    s_add_u32 m0, s67, 52224
    s_nop 0
    buffer_load_dwordx4 v13, s[32:35], s69 offen lds
    s_add_u32 m0, s67, 53248
    s_nop 0
    buffer_load_dwordx4 v14, s[32:35], s69 offen lds
    s_add_u32 m0, s67, 54272
    s_nop 0
    buffer_load_dwordx4 v15, s[32:35], s69 offen lds
    s_getpc_b64 s[90:91]
PC_1:
    s_sub_u32 s90, s90, PC_1-k1_kernel
    s_subb_u32 s91, s91, 0
    v_and_b32 v3, 63, v0
    v_lshlrev_b32 v3, 7, v3
    s_lshl_b32 s92, s27, 13
    v_add_u32 v3, s92, v3
    v_min_u32 v5, K2_END-k1_kernel-4, v3
    global_load_dword v4, v5, s[90:91]
    v_add_u32 v3, 32768, v3
    v_min_u32 v5, K2_END-k1_kernel-4, v3
    global_load_dword v4, v5, s[90:91]
    s_waitcnt vmcnt(18)
    s_barrier
    s_add_u32 s70, s65, 256
    s_add_u32 m0, s68, 32768
    s_nop 0
    buffer_load_dwordx4 v16, s[28:31], s70 offen lds
    s_add_u32 m0, s68, 33792
    s_nop 0
    buffer_load_dwordx4 v17, s[28:31], s70 offen lds
    s_add_u32 m0, s68, 34816
    s_nop 0
    buffer_load_dwordx4 v18, s[28:31], s70 offen lds
    s_add_u32 m0, s68, 35840
    s_nop 0
    buffer_load_dwordx4 v19, s[28:31], s70 offen lds
    s_mul_i32 s69, s66, 3
    s_add_u32 s69, s69, s46
    s_add_u32 m0, s67, 73728
    s_nop 0
    buffer_load_dwordx4 v10, s[32:35], s69 offen lds
    s_add_u32 m0, s67, 74752
    s_nop 0
    buffer_load_dwordx4 v11, s[32:35], s69 offen lds
    s_add_u32 m0, s67, 75776
    s_nop 0
    buffer_load_dwordx4 v12, s[32:35], s69 offen lds
    s_add_u32 m0, s67, 76800
    s_nop 0
    buffer_load_dwordx4 v13, s[32:35], s69 offen lds
    s_add_u32 m0, s67, 77824
    s_nop 0
    buffer_load_dwordx4 v14, s[32:35], s69 offen lds
    s_add_u32 m0, s67, 78848
    s_nop 0
    buffer_load_dwordx4 v15, s[32:35], s69 offen lds
    s_waitcnt vmcnt(22)
    s_barrier
    s_mul_i32 s69, s66, 4
    s_add_u32 s69, s69, s46
    s_add_u32 m0, s67, 0
    s_nop 0
    buffer_load_dwordx4 v10, s[32:35], s69 offen lds
    s_add_u32 m0, s67, 1024
    s_nop 0
    buffer_load_dwordx4 v11, s[32:35], s69 offen lds
    s_add_u32 m0, s67, 2048
    s_nop 0
    buffer_load_dwordx4 v12, s[32:35], s69 offen lds
    s_add_u32 m0, s67, 3072
    s_nop 0
    buffer_load_dwordx4 v13, s[32:35], s69 offen lds
    s_add_u32 m0, s67, 4096
    s_nop 0
    buffer_load_dwordx4 v14, s[32:35], s69 offen lds
    s_add_u32 m0, s67, 5120
    s_nop 0
    buffer_load_dwordx4 v15, s[32:35], s69 offen lds
    s_waitcnt vmcnt(18)
    s_barrier
    s_add_u32 s70, s65, 384
    s_add_u32 m0, s68, 0
    s_nop 0
    buffer_load_dwordx4 v16, s[28:31], s70 offen lds
    s_add_u32 m0, s68, 1024
    s_nop 0
    buffer_load_dwordx4 v17, s[28:31], s70 offen lds
    s_add_u32 m0, s68, 2048
    s_nop 0
    buffer_load_dwordx4 v18, s[28:31], s70 offen lds
    s_add_u32 m0, s68, 3072
    s_nop 0
    buffer_load_dwordx4 v19, s[28:31], s70 offen lds
    s_mul_i32 s69, s66, 5
    s_add_u32 s69, s69, s46
    s_add_u32 m0, s67, 24576
    s_nop 0
    buffer_load_dwordx4 v10, s[32:35], s69 offen lds
    s_add_u32 m0, s67, 25600
    s_nop 0
    buffer_load_dwordx4 v11, s[32:35], s69 offen lds
    s_add_u32 m0, s67, 26624
    s_nop 0
    buffer_load_dwordx4 v12, s[32:35], s69 offen lds
    s_add_u32 m0, s67, 27648
    s_nop 0
    buffer_load_dwordx4 v13, s[32:35], s69 offen lds
    s_add_u32 m0, s67, 28672
    s_nop 0
    buffer_load_dwordx4 v14, s[32:35], s69 offen lds
    s_add_u32 m0, s67, 29696
    s_nop 0
    buffer_load_dwordx4 v15, s[32:35], s69 offen lds
    s_waitcnt vmcnt(16)
    s_barrier
    s_mul_i32 s69, s66, 6
    s_add_u32 s69, s69, s46
    s_add_u32 m0, s67, 49152
    s_nop 0
    buffer_load_dwordx4 v10, s[32:35], s69 offen lds
    s_add_u32 m0, s67, 50176
    s_nop 0
    buffer_load_dwordx4 v11, s[32:35], s69 offen lds
    s_add_u32 m0, s67, 51200
    s_nop 0
    buffer_load_dwordx4 v12, s[32:35], s69 offen lds
    s_add_u32 m0, s67, 52224
    s_nop 0
    buffer_load_dwordx4 v13, s[32:35], s69 offen lds
    s_add_u32 m0, s67, 53248
    s_nop 0
    buffer_load_dwordx4 v14, s[32:35], s69 offen lds
    s_add_u32 m0, s67, 54272
    s_nop 0
    buffer_load_dwordx4 v15, s[32:35], s69 offen lds
    s_waitcnt vmcnt(16)
    s_barrier
    s_add_u32 s70, s65, 512
    s_add_u32 m0, s68, 16384
    s_nop 0
    buffer_load_dwordx4 v16, s[28:31], s70 offen lds
    s_add_u32 m0, s68, 17408
    s_nop 0
    buffer_load_dwordx4 v17, s[28:31], s70 offen lds
    s_add_u32 m0, s68, 18432
    s_nop 0
    buffer_load_dwordx4 v18, s[28:31], s70 offen lds
    s_add_u32 m0, s68, 19456
    s_nop 0
    buffer_load_dwordx4 v19, s[28:31], s70 offen lds
    s_mul_i32 s69, s66, 7
    s_add_u32 s69, s69, s46
    s_add_u32 m0, s67, 73728
    s_nop 0
    buffer_load_dwordx4 v10, s[32:35], s69 offen lds
    s_add_u32 m0, s67, 74752
    s_nop 0
    buffer_load_dwordx4 v11, s[32:35], s69 offen lds
    s_add_u32 m0, s67, 75776
    s_nop 0
    buffer_load_dwordx4 v12, s[32:35], s69 offen lds
    s_add_u32 m0, s67, 76800
    s_nop 0
    buffer_load_dwordx4 v13, s[32:35], s69 offen lds
    s_add_u32 m0, s67, 77824
    s_nop 0
    buffer_load_dwordx4 v14, s[32:35], s69 offen lds
    s_add_u32 m0, s67, 78848
    s_nop 0
    buffer_load_dwordx4 v15, s[32:35], s69 offen lds
    s_waitcnt vmcnt(16)
    s_barrier
    s_mul_i32 s69, s66, 8
    s_add_u32 s69, s69, s46
    s_add_u32 m0, s67, 0
    s_nop 0
    buffer_load_dwordx4 v10, s[32:35], s69 offen lds
    s_add_u32 m0, s67, 1024
    s_nop 0
    buffer_load_dwordx4 v11, s[32:35], s69 offen lds
    s_add_u32 m0, s67, 2048
    s_nop 0
    buffer_load_dwordx4 v12, s[32:35], s69 offen lds
    s_add_u32 m0, s67, 3072
    s_nop 0
    buffer_load_dwordx4 v13, s[32:35], s69 offen lds
    s_add_u32 m0, s67, 4096
    s_nop 0
    buffer_load_dwordx4 v14, s[32:35], s69 offen lds
    s_add_u32 m0, s67, 5120
    s_nop 0
    buffer_load_dwordx4 v15, s[32:35], s69 offen lds
    s_waitcnt vmcnt(16)
    s_barrier
    s_add_u32 s70, s65, 640
    s_add_u32 m0, s68, 32768
    s_nop 0
    buffer_load_dwordx4 v16, s[28:31], s70 offen lds
    s_add_u32 m0, s68, 33792
    s_nop 0
    buffer_load_dwordx4 v17, s[28:31], s70 offen lds
    s_add_u32 m0, s68, 34816
    s_nop 0
    buffer_load_dwordx4 v18, s[28:31], s70 offen lds
    s_add_u32 m0, s68, 35840
    s_nop 0
    buffer_load_dwordx4 v19, s[28:31], s70 offen lds
    s_mul_i32 s69, s66, 9
    s_add_u32 s69, s69, s46
    s_add_u32 m0, s67, 24576
    s_nop 0
    buffer_load_dwordx4 v10, s[32:35], s69 offen lds
    s_add_u32 m0, s67, 25600
    s_nop 0
    buffer_load_dwordx4 v11, s[32:35], s69 offen lds
    s_add_u32 m0, s67, 26624
    s_nop 0
    buffer_load_dwordx4 v12, s[32:35], s69 offen lds
    s_add_u32 m0, s67, 27648
    s_nop 0
    buffer_load_dwordx4 v13, s[32:35], s69 offen lds
    s_add_u32 m0, s67, 28672
    s_nop 0
    buffer_load_dwordx4 v14, s[32:35], s69 offen lds
    s_add_u32 m0, s67, 29696
    s_nop 0
    buffer_load_dwordx4 v15, s[32:35], s69 offen lds
    s_waitcnt vmcnt(16)
    s_barrier
    s_mul_i32 s69, s66, 10
    s_add_u32 s69, s69, s46
    s_add_u32 m0, s67, 49152
    s_nop 0
    buffer_load_dwordx4 v10, s[32:35], s69 offen lds
    s_add_u32 m0, s67, 50176
    s_nop 0
    buffer_load_dwordx4 v11, s[32:35], s69 offen lds
    s_add_u32 m0, s67, 51200
    s_nop 0
    buffer_load_dwordx4 v12, s[32:35], s69 offen lds
    s_add_u32 m0, s67, 52224
    s_nop 0
    buffer_load_dwordx4 v13, s[32:35], s69 offen lds
    s_add_u32 m0, s67, 53248
    s_nop 0
    buffer_load_dwordx4 v14, s[32:35], s69 offen lds
    s_add_u32 m0, s67, 54272
    s_nop 0
    buffer_load_dwordx4 v15, s[32:35], s69 offen lds
    s_waitcnt vmcnt(16)
    s_barrier
    s_add_u32 s70, s65, 768
    s_add_u32 m0, s68, 0
    s_nop 0
    buffer_load_dwordx4 v16, s[28:31], s70 offen lds
    s_add_u32 m0, s68, 1024
    s_nop 0
    buffer_load_dwordx4 v17, s[28:31], s70 offen lds
    s_add_u32 m0, s68, 2048
    s_nop 0
    buffer_load_dwordx4 v18, s[28:31], s70 offen lds
    s_add_u32 m0, s68, 3072
    s_nop 0
    buffer_load_dwordx4 v19, s[28:31], s70 offen lds
    s_mul_i32 s69, s66, 11
    s_add_u32 s69, s69, s46
    s_add_u32 m0, s67, 73728
    s_nop 0
    buffer_load_dwordx4 v10, s[32:35], s69 offen lds
    s_add_u32 m0, s67, 74752
    s_nop 0
    buffer_load_dwordx4 v11, s[32:35], s69 offen lds
    s_add_u32 m0, s67, 75776
    s_nop 0
    buffer_load_dwordx4 v12, s[32:35], s69 offen lds
    s_add_u32 m0, s67, 76800
    s_nop 0
    buffer_load_dwordx4 v13, s[32:35], s69 offen lds
    s_add_u32 m0, s67, 77824
    s_nop 0
    buffer_load_dwordx4 v14, s[32:35], s69 offen lds
    s_add_u32 m0, s67, 78848
    s_nop 0
    buffer_load_dwordx4 v15, s[32:35], s69 offen lds
    s_waitcnt vmcnt(16)
    s_barrier
    s_mul_i32 s69, s66, 12
    s_add_u32 s69, s69, s46
    s_add_u32 m0, s67, 0
    s_nop 0
    buffer_load_dwordx4 v10, s[32:35], s69 offen lds
    s_add_u32 m0, s67, 1024
    s_nop 0
    buffer_load_dwordx4 v11, s[32:35], s69 offen lds
    s_add_u32 m0, s67, 2048
    s_nop 0
    buffer_load_dwordx4 v12, s[32:35], s69 offen lds
    s_add_u32 m0, s67, 3072
    s_nop 0
    buffer_load_dwordx4 v13, s[32:35], s69 offen lds
    s_add_u32 m0, s67, 4096
    s_nop 0
    buffer_load_dwordx4 v14, s[32:35], s69 offen lds
    s_add_u32 m0, s67, 5120
    s_nop 0
    buffer_load_dwordx4 v15, s[32:35], s69 offen lds
    s_waitcnt vmcnt(16)
    s_barrier
    s_add_u32 s70, s65, 896
    s_add_u32 m0, s68, 16384
    s_nop 0
    buffer_load_dwordx4 v16, s[28:31], s70 offen lds
    s_add_u32 m0, s68, 17408
    s_nop 0
    buffer_load_dwordx4 v17, s[28:31], s70 offen lds
    s_add_u32 m0, s68, 18432
    s_nop 0
    buffer_load_dwordx4 v18, s[28:31], s70 offen lds
    s_add_u32 m0, s68, 19456
    s_nop 0
    buffer_load_dwordx4 v19, s[28:31], s70 offen lds
    s_mul_i32 s69, s66, 13
    s_add_u32 s69, s69, s46
    s_add_u32 m0, s67, 24576
    s_nop 0
    buffer_load_dwordx4 v10, s[32:35], s69 offen lds
    s_add_u32 m0, s67, 25600
    s_nop 0
    buffer_load_dwordx4 v11, s[32:35], s69 offen lds
    s_add_u32 m0, s67, 26624
    s_nop 0
    buffer_load_dwordx4 v12, s[32:35], s69 offen lds
    s_add_u32 m0, s67, 27648
    s_nop 0
    buffer_load_dwordx4 v13, s[32:35], s69 offen lds
    s_add_u32 m0, s67, 28672
    s_nop 0
    buffer_load_dwordx4 v14, s[32:35], s69 offen lds
    s_add_u32 m0, s67, 29696
    s_nop 0
    buffer_load_dwordx4 v15, s[32:35], s69 offen lds
    s_waitcnt vmcnt(16)
    s_barrier
    s_mul_i32 s69, s66, 14
    s_add_u32 s69, s69, s46
    s_add_u32 m0, s67, 49152
    s_nop 0
    buffer_load_dwordx4 v10, s[32:35], s69 offen lds
    s_add_u32 m0, s67, 50176
    s_nop 0
    buffer_load_dwordx4 v11, s[32:35], s69 offen lds
    s_add_u32 m0, s67, 51200
    s_nop 0
    buffer_load_dwordx4 v12, s[32:35], s69 offen lds
    s_add_u32 m0, s67, 52224
    s_nop 0
    buffer_load_dwordx4 v13, s[32:35], s69 offen lds
    s_add_u32 m0, s67, 53248
    s_nop 0
    buffer_load_dwordx4 v14, s[32:35], s69 offen lds
    s_add_u32 m0, s67, 54272
    s_nop 0
    buffer_load_dwordx4 v15, s[32:35], s69 offen lds
    s_waitcnt vmcnt(16)
    s_barrier
    s_add_u32 s70, s65, 1024
    s_add_u32 m0, s68, 32768
    s_nop 0
    buffer_load_dwordx4 v16, s[28:31], s70 offen lds
    s_add_u32 m0, s68, 33792
    s_nop 0
    buffer_load_dwordx4 v17, s[28:31], s70 offen lds
    s_add_u32 m0, s68, 34816
    s_nop 0
    buffer_load_dwordx4 v18, s[28:31], s70 offen lds
    s_add_u32 m0, s68, 35840
    s_nop 0
    buffer_load_dwordx4 v19, s[28:31], s70 offen lds
    s_mul_i32 s69, s66, 15
    s_add_u32 s69, s69, s46
    s_add_u32 m0, s67, 73728
    s_nop 0
    buffer_load_dwordx4 v10, s[32:35], s69 offen lds
    s_add_u32 m0, s67, 74752
    s_nop 0
    buffer_load_dwordx4 v11, s[32:35], s69 offen lds
    s_add_u32 m0, s67, 75776
    s_nop 0
    buffer_load_dwordx4 v12, s[32:35], s69 offen lds
    s_add_u32 m0, s67, 76800
    s_nop 0
    buffer_load_dwordx4 v13, s[32:35], s69 offen lds
    s_add_u32 m0, s67, 77824
    s_nop 0
    buffer_load_dwordx4 v14, s[32:35], s69 offen lds
    s_add_u32 m0, s67, 78848
    s_nop 0
    buffer_load_dwordx4 v15, s[32:35], s69 offen lds
    s_waitcnt vmcnt(16)
    s_barrier
    s_mul_i32 s69, s66, 16
    s_add_u32 s69, s69, s46
    s_add_u32 m0, s67, 0
    s_nop 0
    buffer_load_dwordx4 v10, s[32:35], s69 offen lds
    s_add_u32 m0, s67, 1024
    s_nop 0
    buffer_load_dwordx4 v11, s[32:35], s69 offen lds
    s_add_u32 m0, s67, 2048
    s_nop 0
    buffer_load_dwordx4 v12, s[32:35], s69 offen lds
    s_add_u32 m0, s67, 3072
    s_nop 0
    buffer_load_dwordx4 v13, s[32:35], s69 offen lds
    s_add_u32 m0, s67, 4096
    s_nop 0
    buffer_load_dwordx4 v14, s[32:35], s69 offen lds
    s_add_u32 m0, s67, 5120
    s_nop 0
    buffer_load_dwordx4 v15, s[32:35], s69 offen lds
    s_waitcnt vmcnt(16)
    s_barrier
    s_add_u32 s70, s65, 1152
    s_add_u32 m0, s68, 0
    s_nop 0
    buffer_load_dwordx4 v16, s[28:31], s70 offen lds
    s_add_u32 m0, s68, 1024
    s_nop 0
    buffer_load_dwordx4 v17, s[28:31], s70 offen lds
    s_add_u32 m0, s68, 2048
    s_nop 0
    buffer_load_dwordx4 v18, s[28:31], s70 offen lds
    s_add_u32 m0, s68, 3072
    s_nop 0
    buffer_load_dwordx4 v19, s[28:31], s70 offen lds
    s_mul_i32 s69, s66, 17
    s_add_u32 s69, s69, s46
    s_add_u32 m0, s67, 24576
    s_nop 0
    buffer_load_dwordx4 v10, s[32:35], s69 offen lds
    s_add_u32 m0, s67, 25600
    s_nop 0
    buffer_load_dwordx4 v11, s[32:35], s69 offen lds
    s_add_u32 m0, s67, 26624
    s_nop 0
    buffer_load_dwordx4 v12, s[32:35], s69 offen lds
    s_add_u32 m0, s67, 27648
    s_nop 0
    buffer_load_dwordx4 v13, s[32:35], s69 offen lds
    s_add_u32 m0, s67, 28672
    s_nop 0
    buffer_load_dwordx4 v14, s[32:35], s69 offen lds
    s_add_u32 m0, s67, 29696
    s_nop 0
    buffer_load_dwordx4 v15, s[32:35], s69 offen lds
    s_waitcnt vmcnt(16)
    s_barrier
    s_mul_i32 s69, s66, 18
    s_add_u32 s69, s69, s46
    s_add_u32 m0, s67, 49152
    s_nop 0
    buffer_load_dwordx4 v10, s[32:35], s69 offen lds
    s_add_u32 m0, s67, 50176
    s_nop 0
    buffer_load_dwordx4 v11, s[32:35], s69 offen lds
    s_add_u32 m0, s67, 51200
    s_nop 0
    buffer_load_dwordx4 v12, s[32:35], s69 offen lds
    s_add_u32 m0, s67, 52224
    s_nop 0
    buffer_load_dwordx4 v13, s[32:35], s69 offen lds
    s_add_u32 m0, s67, 53248
    s_nop 0
    buffer_load_dwordx4 v14, s[32:35], s69 offen lds
    s_add_u32 m0, s67, 54272
    s_nop 0
    buffer_load_dwordx4 v15, s[32:35], s69 offen lds
    s_waitcnt vmcnt(16)
    s_barrier
    s_mul_i32 s69, s66, 19
    s_add_u32 s69, s69, s46
    s_add_u32 m0, s67, 73728
    s_nop 0
    buffer_load_dwordx4 v10, s[32:35], s69 offen lds
    s_add_u32 m0, s67, 74752
    s_nop 0
    buffer_load_dwordx4 v11, s[32:35], s69 offen lds
    s_add_u32 m0, s67, 75776
    s_nop 0
    buffer_load_dwordx4 v12, s[32:35], s69 offen lds
    s_add_u32 m0, s67, 76800
    s_nop 0
    buffer_load_dwordx4 v13, s[32:35], s69 offen lds
    s_add_u32 m0, s67, 77824
    s_nop 0
    buffer_load_dwordx4 v14, s[32:35], s69 offen lds
    s_add_u32 m0, s67, 78848
    s_nop 0
    buffer_load_dwordx4 v15, s[32:35], s69 offen lds
    s_waitcnt vmcnt(12)
    s_barrier
    s_waitcnt vmcnt(6)
    s_barrier
    s_waitcnt vmcnt(0)
    s_barrier
    s_barrier
    s_endpgm
K1_COMPUTE:
    s_lshr_b32 s44, s26, 1
    s_and_b32 s45, s26, 1
    s_cmp_lt_u32 s43, 9
    s_cbranch_scc0 K1_C_QKV
    s_mul_i32 s46, s45, 6
    s_mov_b32 s47, 0
    s_branch K1_C_GO
K1_C_QKV:
    s_cmp_lt_u32 s43, 13
    s_cbranch_scc0 K1_C_Q
    s_sub_u32 s46, s43, 9
    s_and_b32 s46, s46, 1
    s_lshl_b32 s46, s46, 1
    s_mul_i32 s47, s45, 5
    s_add_u32 s46, s46, s47
    s_mov_b32 s47, 0
    s_branch K1_C_GO
K1_C_Q:
    s_lshl_b32 s46, s45, 1
    s_mul_i32 s47, s45, 12288
K1_C_GO:
    v_and_b32 v8, 15, v1
    v_lshrrev_b32 v9, 4, v1
    s_lshl_b32 s64, s44, 13
    s_add_u32 s64, s64, 98304
    v_lshrrev_b32 v10, 1, v8
    v_xor_b32 v11, v9, v10
    v_lshlrev_b32 v11, 4, v11
    v_lshl_add_u32 v11, v8, 7, v11
    v_add_u32 v2, s64, v11
    v_xor_b32 v3, 64, v2
    v_lshrrev_b32 v10, 2, v8
    v_lshl_add_u32 v11, v9, 3, v10
    v_mul_u32_u24 v11, 384, v11
    v_and_b32 v12, 3, v1
    v_lshl_add_u32 v11, v12, 3, v11
    v_add_u32 v11, s47, v11
    v_lshrrev_b32 v12, 1, v10
    v_and_b32 v13, 1, v9
    v_lshl_or_b32 v12, v13, 1, v12
    s_add_u32 s64, s46, 0
    s_and_b32 s65, s64, 3
    s_lshr_b32 s64, s64, 2
    s_lshl_b32 s64, s64, 7
    v_xor_b32 v13, s65, v12
    v_lshl_add_u32 v13, v13, 5, v11
    v_add_u32 v4, s64, v13
    s_add_u32 s64, s46, 1
    s_and_b32 s65, s64, 3
    s_lshr_b32 s64, s64, 2
    s_lshl_b32 s64, s64, 7
    v_xor_b32 v13, s65, v12
    v_lshl_add_u32 v13, v13, 5, v11
    v_add_u32 v5, s64, v13
    s_add_u32 s64, s46, 2
    s_and_b32 s65, s64, 3
    s_lshr_b32 s64, s64, 2
    s_lshl_b32 s64, s64, 7
    v_xor_b32 v13, s65, v12
    v_lshl_add_u32 v13, v13, 5, v11
    v_add_u32 v6, s64, v13
    s_add_u32 s64, s46, 3
    s_and_b32 s65, s64, 3
    s_lshr_b32 s64, s64, 2
    s_lshl_b32 s64, s64, 7
    v_xor_b32 v13, s65, v12
    v_lshl_add_u32 v13, v13, 5, v11
    v_add_u32 v7, s64, v13
    s_waitcnt lgkmcnt(0)
    s_mov_b32 s28, s4
    s_mov_b32 s29, s5
    s_mov_b32 s30, 0x280000
    s_mov_b32 s31, 0x00020000
    s_mov_b32 s36, s24
    s_mov_b32 s37, s25
    s_mov_b32 s38, 0x10000000
    s_mov_b32 s39, 0x00020000
    s_mov_b32 s48, s18
    s_mov_b32 s49, s19
    s_mov_b32 s50, 0x500
    s_mov_b32 s51, 0x00020000
    s_mov_b32 s52, s22
    s_mov_b32 s53, s23
    s_mov_b32 s54, 0x100
    s_mov_b32 s55, 0x00020000
    s_and_b32 s76, s26, 1
    s_movk_i32 s77, 3456
    s_mul_i32 s78, s43, 384
    s_mov_b32 s32, s6
    s_mov_b32 s33, s7
    s_mov_b32 s34, 0x258000
    s_mov_b32 s35, 0x00020000
    s_cmp_lt_u32 s43, 9
    s_cbranch_scc0 K1_PF_QKV
    s_cmp_eq_u32 s76, 0
    s_cselect_b32 s32, s12, s14
    s_cselect_b32 s33, s13, s15
    s_mov_b32 s34, 0x21c000
    s_branch K1_PF_GO
K1_PF_QKV:
    s_movk_i32 s77, 3840
    s_sub_u32 s78, s43, 9
    s_mul_i32 s78, s78, 320
    s_mul_i32 s79, s76, 1280
    s_add_u32 s78, s78, s79
    s_add_u32 s78, s78, 1280
    s_sub_u32 s79, s43, 13
    s_lshl_b32 s79, s79, 1
    s_add_u32 s79, s79, s76
    s_mul_i32 s79, s79, 320
    s_cmp_lt_u32 s43, 13
    s_cselect_b32 s78, s78, s79
    s_and_b32 s78, s78, 0xffffff80
K1_PF_GO:
    v_min_u32 v10, 23, v1
    v_mul_u32_u24 v11, 0x5556, v10
    v_lshrrev_b32 v11, 16, v11
    v_mul_u32_u24 v12, 3, v11
    v_sub_u32 v12, v10, v12
    s_and_b32 s80, s41, 7
    s_lshl_b32 s80, s80, 3
    v_add_u32 v11, s80, v11
    v_mul_lo_u32 v11, v11, s77
    v_lshl_add_u32 v12, v12, 7, v11
    s_lshl_b32 s79, s77, 6
    s_cmp_lt_u32 s26, 2
    s_cbranch_scc1 K1_PF_W
    s_lshr_b32 s80, s41, 3
    s_lshl_b32 s80, s80, 5
    s_lshl_b32 s81, s76, 4
    s_add_u32 s80, s80, s81
    v_min_u32 v10, 15, v1
    v_add_u32 v10, s80, v10
    v_mul_u32_u24 v12, 1280, v10
    s_mul_i32 s78, s42, 163840
    s_movk_i32 s79, 128
    s_mov_b32 s32, s4
    s_mov_b32 s33, s5
    s_mov_b32 s34, 0x280000
K1_PF_W:
    buffer_load_dword v13, v12, s[32:35], s78 offen
    s_add_u32 s78, s78, s79
    buffer_load_dword v13, v12, s[32:35], s78 offen
    s_add_u32 s78, s78, s79
    v_mov_b32 v64, 0
    v_mov_b32 v65, 0
    v_mov_b32 v66, 0
    v_mov_b32 v67, 0
    v_mov_b32 v68, 0
    v_mov_b32 v69, 0
    v_mov_b32 v70, 0
    v_mov_b32 v71, 0
    v_mov_b32 v72, 0
    v_mov_b32 v73, 0
    v_mov_b32 v74, 0
    v_mov_b32 v75, 0
    v_mov_b32 v76, 0
    v_mov_b32 v77, 0
    v_mov_b32 v78, 0
    v_mov_b32 v79, 0
    v_mov_b32 v80, 0
    v_mov_b32 v81, 0
    v_mov_b32 v82, 0
    v_mov_b32 v83, 0
    v_mov_b32 v84, 0
    v_mov_b32 v85, 0
    v_mov_b32 v86, 0
    v_mov_b32 v87, 0
    v_mov_b32 v88, 0
    v_mov_b32 v89, 0
    v_mov_b32 v90, 0
    v_mov_b32 v91, 0
    v_mov_b32 v92, 0
    v_mov_b32 v93, 0
    v_mov_b32 v94, 0
    v_mov_b32 v95, 0
    v_mov_b32 v96, 0
    v_mov_b32 v97, 0
    v_mov_b32 v98, 0
    v_mov_b32 v99, 0
    v_mov_b32 v100, 0
    v_mov_b32 v101, 0
    v_mov_b32 v102, 0
    v_mov_b32 v103, 0
    v_mov_b32 v104, 0
    v_mov_b32 v105, 0
    v_mov_b32 v106, 0
    v_mov_b32 v107, 0
    v_mov_b32 v108, 0
    v_mov_b32 v109, 0
    v_mov_b32 v110, 0
    v_mov_b32 v111, 0
    v_mov_b32 v112, 0
    v_mov_b32 v113, 0
    v_mov_b32 v114, 0
    v_mov_b32 v115, 0
    v_mov_b32 v116, 0
    v_mov_b32 v117, 0
    v_mov_b32 v118, 0
    v_mov_b32 v119, 0
    v_mov_b32 v120, 0
    v_mov_b32 v121, 0
    v_mov_b32 v122, 0
    v_mov_b32 v123, 0
    v_mov_b32 v124, 0
    v_mov_b32 v125, 0
    v_mov_b32 v126, 0
    v_mov_b32 v127, 0
    v_mov_b32 v128, 0
    v_mov_b32 v129, 0
    v_mov_b32 v130, 0
    v_mov_b32 v131, 0
    v_mov_b32 v132, 0
    v_mov_b32 v133, 0
    v_mov_b32 v134, 0
    v_mov_b32 v135, 0
    v_mov_b32 v136, 0
    v_mov_b32 v137, 0
    v_mov_b32 v138, 0
    v_mov_b32 v139, 0
    v_mov_b32 v140, 0
    v_mov_b32 v141, 0
    v_mov_b32 v142, 0
    v_mov_b32 v143, 0
    v_mov_b32 v144, 0
    v_mov_b32 v145, 0
    v_mov_b32 v146, 0
    v_mov_b32 v147, 0
    v_mov_b32 v148, 0
    v_mov_b32 v149, 0
    v_mov_b32 v150, 0
    v_mov_b32 v151, 0
    v_mov_b32 v152, 0
    v_mov_b32 v153, 0
    v_mov_b32 v154, 0
    v_mov_b32 v155, 0
    v_mov_b32 v156, 0
    v_mov_b32 v157, 0
    v_mov_b32 v158, 0
    v_mov_b32 v159, 0
    v_mov_b32 v160, 0
    v_mov_b32 v161, 0
    v_mov_b32 v162, 0
    v_mov_b32 v163, 0
    v_mov_b32 v164, 0
    v_mov_b32 v165, 0
    v_mov_b32 v166, 0
    v_mov_b32 v167, 0
    v_mov_b32 v168, 0
    v_mov_b32 v169, 0
    v_mov_b32 v170, 0
    v_mov_b32 v171, 0
    v_mov_b32 v172, 0
    v_mov_b32 v173, 0
    v_mov_b32 v174, 0
    v_mov_b32 v175, 0
    v_mov_b32 v176, 0
    v_mov_b32 v177, 0
    v_mov_b32 v178, 0
    v_mov_b32 v179, 0
    v_mov_b32 v180, 0
    v_mov_b32 v181, 0
    v_mov_b32 v182, 0
    v_mov_b32 v183, 0
    v_mov_b32 v184, 0
    v_mov_b32 v185, 0
    v_mov_b32 v186, 0
    v_mov_b32 v187, 0
    v_mov_b32 v188, 0
    v_mov_b32 v189, 0
    v_mov_b32 v190, 0
    v_mov_b32 v191, 0
    v_mov_b32 v192, 0
    v_mov_b32 v193, 0
    v_mov_b32 v194, 0
    v_mov_b32 v195, 0
    v_mov_b32 v196, 0
    v_mov_b32 v197, 0
    v_mov_b32 v198, 0
    v_mov_b32 v199, 0
    v_mov_b32 v200, 0
    v_mov_b32 v201, 0
    v_mov_b32 v202, 0
    v_mov_b32 v203, 0
    v_mov_b32 v204, 0
    v_mov_b32 v205, 0
    v_mov_b32 v206, 0
    v_mov_b32 v207, 0
    v_mov_b32 v208, 0
    v_mov_b32 v209, 0
    v_mov_b32 v210, 0
    v_mov_b32 v211, 0
    v_mov_b32 v212, 0
    v_mov_b32 v213, 0
    v_mov_b32 v214, 0
    v_mov_b32 v215, 0
    v_mov_b32 v216, 0
    v_mov_b32 v217, 0
    v_mov_b32 v218, 0
    v_mov_b32 v219, 0
    v_mov_b32 v220, 0
    v_mov_b32 v221, 0
    v_mov_b32 v222, 0
    v_mov_b32 v223, 0
    v_mov_b32 v224, 0
    v_mov_b32 v225, 0
    v_mov_b32 v226, 0
    v_mov_b32 v227, 0
    v_mov_b32 v228, 0
    v_mov_b32 v229, 0
    v_mov_b32 v230, 0
    v_mov_b32 v231, 0
    v_mov_b32 v232, 0
    v_mov_b32 v233, 0
    v_mov_b32 v234, 0
    v_mov_b32 v235, 0
    v_mov_b32 v236, 0
    v_mov_b32 v237, 0
    v_mov_b32 v238, 0
    v_mov_b32 v239, 0
    v_mov_b32 v240, 0
    v_mov_b32 v241, 0
    v_mov_b32 v242, 0
    v_mov_b32 v243, 0
    v_mov_b32 v244, 0
    v_mov_b32 v245, 0
    v_mov_b32 v246, 0
    v_mov_b32 v247, 0
    v_mov_b32 v248, 0
    v_mov_b32 v249, 0
    v_mov_b32 v250, 0
    v_mov_b32 v251, 0
    v_mov_b32 v252, 0
    v_mov_b32 v253, 0
    v_mov_b32 v254, 0
    v_mov_b32 v255, 0
    s_mov_b32 s70, 0
    s_mov_b32 s71, 10
    s_mov_b32 s75, 49152
    s_cmp_lt_u32 s43, 9
    s_cbranch_scc1 K1_GU
    s_cmp_lt_u32 s43, 13
    s_cbranch_scc1 K1_KV
    s_branch K1_Q
K1_GU:
    s_barrier
    ds_read_b128 v[16:19], v2 offset:0
    ds_read_b128 v[20:23], v2 offset:2048
    ds_read_b128 v[24:27], v2 offset:4096
    ds_read_b128 v[28:31], v2 offset:6144
    ds_read_b64_tr_b16 v[48:49], v4 offset:0
    ds_read_b64_tr_b16 v[50:51], v4 offset:1536
    ds_read_b64_tr_b16 v[52:53], v4 offset:12288
    ds_read_b64_tr_b16 v[54:55], v4 offset:13824
    ds_read_b64_tr_b16 v[56:57], v5 offset:0
    ds_read_b64_tr_b16 v[58:59], v5 offset:1536
K1_LOOP_gu:
    buffer_load_dword v13, v12, s[32:35], s78 offen
    s_add_u32 s78, s78, s79
    s_waitcnt lgkmcnt(4)
    v_mfma_f32_16x16x32_bf16 v[64:67], v[48:51], v[16:19], v[64:67]
    ds_read_b64_tr_b16 v[60:61], v5 offset:12288
    v_mfma_f32_16x16x32_bf16 v[68:71], v[48:51], v[20:23], v[68:71]
    ds_read_b64_tr_b16 v[62:63], v5 offset:13824
    v_mfma_f32_16x16x32_bf16 v[72:75], v[48:51], v[24:27], v[72:75]
    v_mfma_f32_16x16x32_bf16 v[76:79], v[48:51], v[28:31], v[76:79]
    s_waitcnt lgkmcnt(4)
    v_mfma_f32_16x16x32_bf16 v[80:83], v[52:55], v[16:19], v[80:83]
    ds_read_b64_tr_b16 v[48:49], v6 offset:0
    v_mfma_f32_16x16x32_bf16 v[84:87], v[52:55], v[20:23], v[84:87]
    ds_read_b64_tr_b16 v[50:51], v6 offset:1536
    v_mfma_f32_16x16x32_bf16 v[88:91], v[52:55], v[24:27], v[88:91]
    v_mfma_f32_16x16x32_bf16 v[92:95], v[52:55], v[28:31], v[92:95]
    s_waitcnt lgkmcnt(4)
    v_mfma_f32_16x16x32_bf16 v[96:99], v[56:59], v[16:19], v[96:99]
    ds_read_b64_tr_b16 v[52:53], v6 offset:12288
    v_mfma_f32_16x16x32_bf16 v[100:103], v[56:59], v[20:23], v[100:103]
    ds_read_b64_tr_b16 v[54:55], v6 offset:13824
    v_mfma_f32_16x16x32_bf16 v[104:107], v[56:59], v[24:27], v[104:107]
    v_mfma_f32_16x16x32_bf16 v[108:111], v[56:59], v[28:31], v[108:111]
    s_waitcnt lgkmcnt(4)
    v_mfma_f32_16x16x32_bf16 v[112:115], v[60:63], v[16:19], v[112:115]
    ds_read_b64_tr_b16 v[56:57], v7 offset:0
    v_mfma_f32_16x16x32_bf16 v[116:119], v[60:63], v[20:23], v[116:119]
    ds_read_b64_tr_b16 v[58:59], v7 offset:1536
    v_mfma_f32_16x16x32_bf16 v[120:123], v[60:63], v[24:27], v[120:123]
    v_mfma_f32_16x16x32_bf16 v[124:127], v[60:63], v[28:31], v[124:127]
    s_waitcnt lgkmcnt(4)
    v_mfma_f32_16x16x32_bf16 v[128:131], v[48:51], v[16:19], v[128:131]
    ds_read_b64_tr_b16 v[60:61], v7 offset:12288
    v_mfma_f32_16x16x32_bf16 v[132:135], v[48:51], v[20:23], v[132:135]
    ds_read_b64_tr_b16 v[62:63], v7 offset:13824
    v_mfma_f32_16x16x32_bf16 v[136:139], v[48:51], v[24:27], v[136:139]
    v_mfma_f32_16x16x32_bf16 v[140:143], v[48:51], v[28:31], v[140:143]
    s_waitcnt lgkmcnt(4)
    v_mfma_f32_16x16x32_bf16 v[144:147], v[52:55], v[16:19], v[144:147]
    ds_read_b64_tr_b16 v[48:49], v4 offset:128
    v_mfma_f32_16x16x32_bf16 v[148:151], v[52:55], v[20:23], v[148:151]
    ds_read_b64_tr_b16 v[50:51], v4 offset:1664
    v_mfma_f32_16x16x32_bf16 v[152:155], v[52:55], v[24:27], v[152:155]
    v_mfma_f32_16x16x32_bf16 v[156:159], v[52:55], v[28:31], v[156:159]
    s_waitcnt lgkmcnt(4)
    v_mfma_f32_16x16x32_bf16 v[160:163], v[56:59], v[16:19], v[160:163]
    ds_read_b64_tr_b16 v[52:53], v4 offset:12416
    v_mfma_f32_16x16x32_bf16 v[164:167], v[56:59], v[20:23], v[164:167]
    ds_read_b64_tr_b16 v[54:55], v4 offset:13952
    v_mfma_f32_16x16x32_bf16 v[168:171], v[56:59], v[24:27], v[168:171]
    v_mfma_f32_16x16x32_bf16 v[172:175], v[56:59], v[28:31], v[172:175]
    s_waitcnt lgkmcnt(4)
    v_mfma_f32_16x16x32_bf16 v[176:179], v[60:63], v[16:19], v[176:179]
    ds_read_b64_tr_b16 v[56:57], v5 offset:128
    v_mfma_f32_16x16x32_bf16 v[180:183], v[60:63], v[20:23], v[180:183]
    ds_read_b64_tr_b16 v[58:59], v5 offset:1664
    v_mfma_f32_16x16x32_bf16 v[184:187], v[60:63], v[24:27], v[184:187]
    v_mfma_f32_16x16x32_bf16 v[188:191], v[60:63], v[28:31], v[188:191]
    s_waitcnt lgkmcnt(4)
    v_mfma_f32_16x16x32_bf16 v[192:195], v[48:51], v[16:19], v[192:195]
    ds_read_b64_tr_b16 v[60:61], v5 offset:12416
    v_mfma_f32_16x16x32_bf16 v[196:199], v[48:51], v[20:23], v[196:199]
    ds_read_b64_tr_b16 v[62:63], v5 offset:13952
    v_mfma_f32_16x16x32_bf16 v[200:203], v[48:51], v[24:27], v[200:203]
    v_mfma_f32_16x16x32_bf16 v[204:207], v[48:51], v[28:31], v[204:207]
    s_waitcnt lgkmcnt(4)
    v_mfma_f32_16x16x32_bf16 v[208:211], v[52:55], v[16:19], v[208:211]
    v_mfma_f32_16x16x32_bf16 v[212:215], v[52:55], v[20:23], v[212:215]
    v_mfma_f32_16x16x32_bf16 v[216:219], v[52:55], v[24:27], v[216:219]
    v_mfma_f32_16x16x32_bf16 v[220:223], v[52:55], v[28:31], v[220:223]
    s_waitcnt lgkmcnt(0)
    s_barrier
    v_mfma_f32_16x16x32_bf16 v[224:227], v[56:59], v[16:19], v[224:227]
    ds_read_b128 v[32:35], v3 offset:0
    ds_read_b128 v[36:39], v3 offset:2048
    v_mfma_f32_16x16x32_bf16 v[228:231], v[56:59], v[20:23], v[228:231]
    ds_read_b128 v[40:43], v3 offset:4096
    ds_read_b128 v[44:47], v3 offset:6144
    v_mfma_f32_16x16x32_bf16 v[232:235], v[56:59], v[24:27], v[232:235]
    ds_read_b64_tr_b16 v[48:49], v4 offset:24576
    ds_read_b64_tr_b16 v[50:51], v4 offset:26112
    v_mfma_f32_16x16x32_bf16 v[236:239], v[56:59], v[28:31], v[236:239]
    ds_read_b64_tr_b16 v[52:53], v4 offset:36864
    ds_read_b64_tr_b16 v[54:55], v4 offset:38400
    v_mfma_f32_16x16x32_bf16 v[240:243], v[60:63], v[16:19], v[240:243]
    ds_read_b64_tr_b16 v[56:57], v5 offset:24576
    v_mfma_f32_16x16x32_bf16 v[244:247], v[60:63], v[20:23], v[244:247]
    ds_read_b64_tr_b16 v[58:59], v5 offset:26112
    v_mfma_f32_16x16x32_bf16 v[248:251], v[60:63], v[24:27], v[248:251]
    v_mfma_f32_16x16x32_bf16 v[252:255], v[60:63], v[28:31], v[252:255]
    s_waitcnt lgkmcnt(4)
    v_mfma_f32_16x16x32_bf16 v[64:67], v[48:51], v[32:35], v[64:67]
    ds_read_b64_tr_b16 v[60:61], v5 offset:36864
    v_mfma_f32_16x16x32_bf16 v[68:71], v[48:51], v[36:39], v[68:71]
    ds_read_b64_tr_b16 v[62:63], v5 offset:38400
    v_mfma_f32_16x16x32_bf16 v[72:75], v[48:51], v[40:43], v[72:75]
    v_mfma_f32_16x16x32_bf16 v[76:79], v[48:51], v[44:47], v[76:79]
    s_waitcnt lgkmcnt(4)
    v_mfma_f32_16x16x32_bf16 v[80:83], v[52:55], v[32:35], v[80:83]
    ds_read_b64_tr_b16 v[48:49], v6 offset:24576
    v_mfma_f32_16x16x32_bf16 v[84:87], v[52:55], v[36:39], v[84:87]
    ds_read_b64_tr_b16 v[50:51], v6 offset:26112
    v_mfma_f32_16x16x32_bf16 v[88:91], v[52:55], v[40:43], v[88:91]
    v_mfma_f32_16x16x32_bf16 v[92:95], v[52:55], v[44:47], v[92:95]
    s_waitcnt lgkmcnt(4)
    v_mfma_f32_16x16x32_bf16 v[96:99], v[56:59], v[32:35], v[96:99]
    ds_read_b64_tr_b16 v[52:53], v6 offset:36864
    v_mfma_f32_16x16x32_bf16 v[100:103], v[56:59], v[36:39], v[100:103]
    ds_read_b64_tr_b16 v[54:55], v6 offset:38400
    v_mfma_f32_16x16x32_bf16 v[104:107], v[56:59], v[40:43], v[104:107]
    v_mfma_f32_16x16x32_bf16 v[108:111], v[56:59], v[44:47], v[108:111]
    s_waitcnt lgkmcnt(4)
    v_mfma_f32_16x16x32_bf16 v[112:115], v[60:63], v[32:35], v[112:115]
    ds_read_b64_tr_b16 v[56:57], v7 offset:24576
    v_mfma_f32_16x16x32_bf16 v[116:119], v[60:63], v[36:39], v[116:119]
    ds_read_b64_tr_b16 v[58:59], v7 offset:26112
    v_mfma_f32_16x16x32_bf16 v[120:123], v[60:63], v[40:43], v[120:123]
    v_mfma_f32_16x16x32_bf16 v[124:127], v[60:63], v[44:47], v[124:127]
    s_waitcnt lgkmcnt(4)
    v_mfma_f32_16x16x32_bf16 v[128:131], v[48:51], v[32:35], v[128:131]
    ds_read_b64_tr_b16 v[60:61], v7 offset:36864
    v_mfma_f32_16x16x32_bf16 v[132:135], v[48:51], v[36:39], v[132:135]
    ds_read_b64_tr_b16 v[62:63], v7 offset:38400
    v_mfma_f32_16x16x32_bf16 v[136:139], v[48:51], v[40:43], v[136:139]
    v_mfma_f32_16x16x32_bf16 v[140:143], v[48:51], v[44:47], v[140:143]
    s_waitcnt lgkmcnt(4)
    v_mfma_f32_16x16x32_bf16 v[144:147], v[52:55], v[32:35], v[144:147]
    ds_read_b64_tr_b16 v[48:49], v4 offset:24704
    v_mfma_f32_16x16x32_bf16 v[148:151], v[52:55], v[36:39], v[148:151]
    ds_read_b64_tr_b16 v[50:51], v4 offset:26240
    v_mfma_f32_16x16x32_bf16 v[152:155], v[52:55], v[40:43], v[152:155]
    v_mfma_f32_16x16x32_bf16 v[156:159], v[52:55], v[44:47], v[156:159]
    s_waitcnt lgkmcnt(4)
    v_mfma_f32_16x16x32_bf16 v[160:163], v[56:59], v[32:35], v[160:163]
    ds_read_b64_tr_b16 v[52:53], v4 offset:36992
    v_mfma_f32_16x16x32_bf16 v[164:167], v[56:59], v[36:39], v[164:167]
    ds_read_b64_tr_b16 v[54:55], v4 offset:38528
    v_mfma_f32_16x16x32_bf16 v[168:171], v[56:59], v[40:43], v[168:171]
    v_mfma_f32_16x16x32_bf16 v[172:175], v[56:59], v[44:47], v[172:175]
    s_waitcnt lgkmcnt(4)
    v_mfma_f32_16x16x32_bf16 v[176:179], v[60:63], v[32:35], v[176:179]
    ds_read_b64_tr_b16 v[56:57], v5 offset:24704
    v_mfma_f32_16x16x32_bf16 v[180:183], v[60:63], v[36:39], v[180:183]
    ds_read_b64_tr_b16 v[58:59], v5 offset:26240
    v_mfma_f32_16x16x32_bf16 v[184:187], v[60:63], v[40:43], v[184:187]
    v_mfma_f32_16x16x32_bf16 v[188:191], v[60:63], v[44:47], v[188:191]
    s_waitcnt lgkmcnt(4)
    v_mfma_f32_16x16x32_bf16 v[192:195], v[48:51], v[32:35], v[192:195]
    ds_read_b64_tr_b16 v[60:61], v5 offset:36992
    v_mfma_f32_16x16x32_bf16 v[196:199], v[48:51], v[36:39], v[196:199]
    ds_read_b64_tr_b16 v[62:63], v5 offset:38528
    v_mfma_f32_16x16x32_bf16 v[200:203], v[48:51], v[40:43], v[200:203]
    v_mfma_f32_16x16x32_bf16 v[204:207], v[48:51], v[44:47], v[204:207]
    s_waitcnt lgkmcnt(4)
    v_mfma_f32_16x16x32_bf16 v[208:211], v[52:55], v[32:35], v[208:211]
    v_mfma_f32_16x16x32_bf16 v[212:215], v[52:55], v[36:39], v[212:215]
    v_mfma_f32_16x16x32_bf16 v[216:219], v[52:55], v[40:43], v[216:219]
    v_mfma_f32_16x16x32_bf16 v[220:223], v[52:55], v[44:47], v[220:223]
    s_waitcnt lgkmcnt(0)
    s_barrier
    v_add_u32 v4, s75, v4
    v_add_u32 v5, s75, v5
    v_add_u32 v6, s75, v6
    v_add_u32 v7, s75, v7
    s_sub_u32 s75, 0, s75
    s_add_u32 s70, s70, 16384
    s_cmp_eq_u32 s70, 49152
    s_cselect_b32 s73, s70, 0
    s_sub_u32 s70, s70, s73
    s_sub_u32 s73, 16384, s73
    v_add_u32 v2, s73, v2
    v_add_u32 v3, s73, v3
    v_mfma_f32_16x16x32_bf16 v[224:227], v[56:59], v[32:35], v[224:227]
    ds_read_b128 v[16:19], v2 offset:0
    ds_read_b128 v[20:23], v2 offset:2048
    v_mfma_f32_16x16x32_bf16 v[228:231], v[56:59], v[36:39], v[228:231]
    ds_read_b128 v[24:27], v2 offset:4096
    ds_read_b128 v[28:31], v2 offset:6144
    v_mfma_f32_16x16x32_bf16 v[232:235], v[56:59], v[40:43], v[232:235]
    ds_read_b64_tr_b16 v[48:49], v4 offset:0
    ds_read_b64_tr_b16 v[50:51], v4 offset:1536
    v_mfma_f32_16x16x32_bf16 v[236:239], v[56:59], v[44:47], v[236:239]
    ds_read_b64_tr_b16 v[52:53], v4 offset:12288
    ds_read_b64_tr_b16 v[54:55], v4 offset:13824
    v_mfma_f32_16x16x32_bf16 v[240:243], v[60:63], v[32:35], v[240:243]
    ds_read_b64_tr_b16 v[56:57], v5 offset:0
    v_mfma_f32_16x16x32_bf16 v[244:247], v[60:63], v[36:39], v[244:247]
    ds_read_b64_tr_b16 v[58:59], v5 offset:1536
    v_mfma_f32_16x16x32_bf16 v[248:251], v[60:63], v[40:43], v[248:251]
    v_mfma_f32_16x16x32_bf16 v[252:255], v[60:63], v[44:47], v[252:255]
    s_sub_u32 s71, s71, 1
    s_cmp_lg_u32 s71, 0
    s_cbranch_scc1 K1_LOOP_gu
    s_waitcnt lgkmcnt(0) vmcnt(0)
    s_nop 7
    s_mov_b32 s64, 0xbfb8aa3b
    s_mov_b32 s65, 0xbfb8aa3b
    s_mov_b32 s66, 1.0
    s_mov_b32 s67, 1.0
    s_lshl_b32 s68, s42, 3
    s_lshl_b32 s69, s44, 2
    s_add_u32 s68, s68, s69
    s_mul_i32 s68, s68, 74
    s_mul_i32 s69, s43, 6
    s_add_u32 s68, s68, s69
    s_mul_i32 s69, s45, 3
    s_add_u32 s68, s68, s69
    s_lshl_b32 s68, s68, 10
    v_lshlrev_b32 v8, 4, v1
    v_pk_mul_f32 v[16:17], v[64:65], s[64:65]
    v_pk_mul_f32 v[18:19], v[66:67], s[64:65]
    v_pk_mul_f32 v[20:21], v[96:97], s[64:65]
    v_pk_mul_f32 v[22:23], v[98:99], s[64:65]
    v_exp_f32 v16, v16
    v_exp_f32 v17, v17
    v_exp_f32 v18, v18
    v_exp_f32 v19, v19
    v_exp_f32 v20, v20
    v_exp_f32 v21, v21
    v_exp_f32 v22, v22
    v_exp_f32 v23, v23
    v_pk_add_f32 v[16:17], v[16:17], s[66:67]
    v_pk_add_f32 v[18:19], v[18:19], s[66:67]
    v_pk_add_f32 v[20:21], v[20:21], s[66:67]
    v_pk_add_f32 v[22:23], v[22:23], s[66:67]
    v_rcp_f32 v16, v16
    v_rcp_f32 v17, v17
    v_rcp_f32 v18, v18
    v_rcp_f32 v19, v19
    v_rcp_f32 v20, v20
    v_rcp_f32 v21, v21
    v_rcp_f32 v22, v22
    v_rcp_f32 v23, v23
    v_pk_mul_f32 v[16:17], v[16:17], v[80:81]
    v_pk_mul_f32 v[18:19], v[18:19], v[82:83]
    v_pk_mul_f32 v[20:21], v[20:21], v[112:113]
    v_pk_mul_f32 v[22:23], v[22:23], v[114:115]
    v_cvt_pk_bf16_f32 v24, v16, v17
    v_cvt_pk_bf16_f32 v25, v18, v19
    v_cvt_pk_bf16_f32 v26, v20, v21
    v_cvt_pk_bf16_f32 v27, v22, v23
    s_add_u32 s69, s68, 0
    buffer_store_dwordx4 v[24:27], v8, s[36:39], s69 offen sc0 sc1
    v_pk_mul_f32 v[32:33], v[128:129], s[64:65]
    v_pk_mul_f32 v[34:35], v[130:131], s[64:65]
    v_pk_mul_f32 v[36:37], v[160:161], s[64:65]
    v_pk_mul_f32 v[38:39], v[162:163], s[64:65]
    v_exp_f32 v32, v32
    v_exp_f32 v33, v33
    v_exp_f32 v34, v34
    v_exp_f32 v35, v35
    v_exp_f32 v36, v36
    v_exp_f32 v37, v37
    v_exp_f32 v38, v38
    v_exp_f32 v39, v39
    v_pk_add_f32 v[32:33], v[32:33], s[66:67]
    v_pk_add_f32 v[34:35], v[34:35], s[66:67]
    v_pk_add_f32 v[36:37], v[36:37], s[66:67]
    v_pk_add_f32 v[38:39], v[38:39], s[66:67]
    v_rcp_f32 v32, v32
    v_rcp_f32 v33, v33
    v_rcp_f32 v34, v34
    v_rcp_f32 v35, v35
    v_rcp_f32 v36, v36
    v_rcp_f32 v37, v37
    v_rcp_f32 v38, v38
    v_rcp_f32 v39, v39
    v_pk_mul_f32 v[32:33], v[32:33], v[144:145]
    v_pk_mul_f32 v[34:35], v[34:35], v[146:147]
    v_pk_mul_f32 v[36:37], v[36:37], v[176:177]
    v_pk_mul_f32 v[38:39], v[38:39], v[178:179]
    v_cvt_pk_bf16_f32 v40, v32, v33
    v_cvt_pk_bf16_f32 v41, v34, v35
    v_cvt_pk_bf16_f32 v42, v36, v37
    v_cvt_pk_bf16_f32 v43, v38, v39
    s_add_u32 s69, s68, 1024
    buffer_store_dwordx4 v[40:43], v8, s[36:39], s69 offen sc0 sc1
    v_pk_mul_f32 v[16:17], v[192:193], s[64:65]
    v_pk_mul_f32 v[18:19], v[194:195], s[64:65]
    v_pk_mul_f32 v[20:21], v[224:225], s[64:65]
    v_pk_mul_f32 v[22:23], v[226:227], s[64:65]
    v_exp_f32 v16, v16
    v_exp_f32 v17, v17
    v_exp_f32 v18, v18
    v_exp_f32 v19, v19
    v_exp_f32 v20, v20
    v_exp_f32 v21, v21
    v_exp_f32 v22, v22
    v_exp_f32 v23, v23
    v_pk_add_f32 v[16:17], v[16:17], s[66:67]
    v_pk_add_f32 v[18:19], v[18:19], s[66:67]
    v_pk_add_f32 v[20:21], v[20:21], s[66:67]
    v_pk_add_f32 v[22:23], v[22:23], s[66:67]
    v_rcp_f32 v16, v16
    v_rcp_f32 v17, v17
    v_rcp_f32 v18, v18
    v_rcp_f32 v19, v19
    v_rcp_f32 v20, v20
    v_rcp_f32 v21, v21
    v_rcp_f32 v22, v22
    v_rcp_f32 v23, v23
    v_pk_mul_f32 v[16:17], v[16:17], v[208:209]
    v_pk_mul_f32 v[18:19], v[18:19], v[210:211]
    v_pk_mul_f32 v[20:21], v[20:21], v[240:241]
    v_pk_mul_f32 v[22:23], v[22:23], v[242:243]
    v_cvt_pk_bf16_f32 v24, v16, v17
    v_cvt_pk_bf16_f32 v25, v18, v19
    v_cvt_pk_bf16_f32 v26, v20, v21
    v_cvt_pk_bf16_f32 v27, v22, v23
    s_add_u32 s69, s68, 2048
    buffer_store_dwordx4 v[24:27], v8, s[36:39], s69 offen sc0 sc1
    v_pk_mul_f32 v[32:33], v[68:69], s[64:65]
    v_pk_mul_f32 v[34:35], v[70:71], s[64:65]
    v_pk_mul_f32 v[36:37], v[100:101], s[64:65]
    v_pk_mul_f32 v[38:39], v[102:103], s[64:65]
    v_exp_f32 v32, v32
    v_exp_f32 v33, v33
    v_exp_f32 v34, v34
    v_exp_f32 v35, v35
    v_exp_f32 v36, v36
    v_exp_f32 v37, v37
    v_exp_f32 v38, v38
    v_exp_f32 v39, v39
    v_pk_add_f32 v[32:33], v[32:33], s[66:67]
    v_pk_add_f32 v[34:35], v[34:35], s[66:67]
    v_pk_add_f32 v[36:37], v[36:37], s[66:67]
    v_pk_add_f32 v[38:39], v[38:39], s[66:67]
    v_rcp_f32 v32, v32
    v_rcp_f32 v33, v33
    v_rcp_f32 v34, v34
    v_rcp_f32 v35, v35
    v_rcp_f32 v36, v36
    v_rcp_f32 v37, v37
    v_rcp_f32 v38, v38
    v_rcp_f32 v39, v39
    v_pk_mul_f32 v[32:33], v[32:33], v[84:85]
    v_pk_mul_f32 v[34:35], v[34:35], v[86:87]
    v_pk_mul_f32 v[36:37], v[36:37], v[116:117]
    v_pk_mul_f32 v[38:39], v[38:39], v[118:119]
    v_cvt_pk_bf16_f32 v40, v32, v33
    v_cvt_pk_bf16_f32 v41, v34, v35
    v_cvt_pk_bf16_f32 v42, v36, v37
    v_cvt_pk_bf16_f32 v43, v38, v39
    s_add_u32 s69, s68, 75776
    buffer_store_dwordx4 v[40:43], v8, s[36:39], s69 offen sc0 sc1
    v_pk_mul_f32 v[16:17], v[132:133], s[64:65]
    v_pk_mul_f32 v[18:19], v[134:135], s[64:65]
    v_pk_mul_f32 v[20:21], v[164:165], s[64:65]
    v_pk_mul_f32 v[22:23], v[166:167], s[64:65]
    v_exp_f32 v16, v16
    v_exp_f32 v17, v17
    v_exp_f32 v18, v18
    v_exp_f32 v19, v19
    v_exp_f32 v20, v20
    v_exp_f32 v21, v21
    v_exp_f32 v22, v22
    v_exp_f32 v23, v23
    v_pk_add_f32 v[16:17], v[16:17], s[66:67]
    v_pk_add_f32 v[18:19], v[18:19], s[66:67]
    v_pk_add_f32 v[20:21], v[20:21], s[66:67]
    v_pk_add_f32 v[22:23], v[22:23], s[66:67]
    v_rcp_f32 v16, v16
    v_rcp_f32 v17, v17
    v_rcp_f32 v18, v18
    v_rcp_f32 v19, v19
    v_rcp_f32 v20, v20
    v_rcp_f32 v21, v21
    v_rcp_f32 v22, v22
    v_rcp_f32 v23, v23
    v_pk_mul_f32 v[16:17], v[16:17], v[148:149]
    v_pk_mul_f32 v[18:19], v[18:19], v[150:151]
    v_pk_mul_f32 v[20:21], v[20:21], v[180:181]
    v_pk_mul_f32 v[22:23], v[22:23], v[182:183]
    v_cvt_pk_bf16_f32 v24, v16, v17
    v_cvt_pk_bf16_f32 v25, v18, v19
    v_cvt_pk_bf16_f32 v26, v20, v21
    v_cvt_pk_bf16_f32 v27, v22, v23
    s_add_u32 s69, s68, 76800
    buffer_store_dwordx4 v[24:27], v8, s[36:39], s69 offen sc0 sc1
    v_pk_mul_f32 v[32:33], v[196:197], s[64:65]
    v_pk_mul_f32 v[34:35], v[198:199], s[64:65]
    v_pk_mul_f32 v[36:37], v[228:229], s[64:65]
    v_pk_mul_f32 v[38:39], v[230:231], s[64:65]
    v_exp_f32 v32, v32
    v_exp_f32 v33, v33
    v_exp_f32 v34, v34
    v_exp_f32 v35, v35
    v_exp_f32 v36, v36
    v_exp_f32 v37, v37
    v_exp_f32 v38, v38
    v_exp_f32 v39, v39
    v_pk_add_f32 v[32:33], v[32:33], s[66:67]
    v_pk_add_f32 v[34:35], v[34:35], s[66:67]
    v_pk_add_f32 v[36:37], v[36:37], s[66:67]
    v_pk_add_f32 v[38:39], v[38:39], s[66:67]
    v_rcp_f32 v32, v32
    v_rcp_f32 v33, v33
    v_rcp_f32 v34, v34
    v_rcp_f32 v35, v35
    v_rcp_f32 v36, v36
    v_rcp_f32 v37, v37
    v_rcp_f32 v38, v38
    v_rcp_f32 v39, v39
    v_pk_mul_f32 v[32:33], v[32:33], v[212:213]
    v_pk_mul_f32 v[34:35], v[34:35], v[214:215]
    v_pk_mul_f32 v[36:37], v[36:37], v[244:245]
    v_pk_mul_f32 v[38:39], v[38:39], v[246:247]
    v_cvt_pk_bf16_f32 v40, v32, v33
    v_cvt_pk_bf16_f32 v41, v34, v35
    v_cvt_pk_bf16_f32 v42, v36, v37
    v_cvt_pk_bf16_f32 v43, v38, v39
    s_add_u32 s69, s68, 77824
    buffer_store_dwordx4 v[40:43], v8, s[36:39], s69 offen sc0 sc1
    v_pk_mul_f32 v[16:17], v[72:73], s[64:65]
    v_pk_mul_f32 v[18:19], v[74:75], s[64:65]
    v_pk_mul_f32 v[20:21], v[104:105], s[64:65]
    v_pk_mul_f32 v[22:23], v[106:107], s[64:65]
    v_exp_f32 v16, v16
    v_exp_f32 v17, v17
    v_exp_f32 v18, v18
    v_exp_f32 v19, v19
    v_exp_f32 v20, v20
    v_exp_f32 v21, v21
    v_exp_f32 v22, v22
    v_exp_f32 v23, v23
    v_pk_add_f32 v[16:17], v[16:17], s[66:67]
    v_pk_add_f32 v[18:19], v[18:19], s[66:67]
    v_pk_add_f32 v[20:21], v[20:21], s[66:67]
    v_pk_add_f32 v[22:23], v[22:23], s[66:67]
    v_rcp_f32 v16, v16
    v_rcp_f32 v17, v17
    v_rcp_f32 v18, v18
    v_rcp_f32 v19, v19
    v_rcp_f32 v20, v20
    v_rcp_f32 v21, v21
    v_rcp_f32 v22, v22
    v_rcp_f32 v23, v23
    v_pk_mul_f32 v[16:17], v[16:17], v[88:89]
    v_pk_mul_f32 v[18:19], v[18:19], v[90:91]
    v_pk_mul_f32 v[20:21], v[20:21], v[120:121]
    v_pk_mul_f32 v[22:23], v[22:23], v[122:123]
    v_cvt_pk_bf16_f32 v24, v16, v17
    v_cvt_pk_bf16_f32 v25, v18, v19
    v_cvt_pk_bf16_f32 v26, v20, v21
    v_cvt_pk_bf16_f32 v27, v22, v23
    s_add_u32 s69, s68, 151552
    buffer_store_dwordx4 v[24:27], v8, s[36:39], s69 offen sc0 sc1
    v_pk_mul_f32 v[32:33], v[136:137], s[64:65]
    v_pk_mul_f32 v[34:35], v[138:139], s[64:65]
    v_pk_mul_f32 v[36:37], v[168:169], s[64:65]
    v_pk_mul_f32 v[38:39], v[170:171], s[64:65]
    v_exp_f32 v32, v32
    v_exp_f32 v33, v33
    v_exp_f32 v34, v34
    v_exp_f32 v35, v35
    v_exp_f32 v36, v36
    v_exp_f32 v37, v37
    v_exp_f32 v38, v38
    v_exp_f32 v39, v39
    v_pk_add_f32 v[32:33], v[32:33], s[66:67]
    v_pk_add_f32 v[34:35], v[34:35], s[66:67]
    v_pk_add_f32 v[36:37], v[36:37], s[66:67]
    v_pk_add_f32 v[38:39], v[38:39], s[66:67]
    v_rcp_f32 v32, v32
    v_rcp_f32 v33, v33
    v_rcp_f32 v34, v34
    v_rcp_f32 v35, v35
    v_rcp_f32 v36, v36
    v_rcp_f32 v37, v37
    v_rcp_f32 v38, v38
    v_rcp_f32 v39, v39
    v_pk_mul_f32 v[32:33], v[32:33], v[152:153]
    v_pk_mul_f32 v[34:35], v[34:35], v[154:155]
    v_pk_mul_f32 v[36:37], v[36:37], v[184:185]
    v_pk_mul_f32 v[38:39], v[38:39], v[186:187]
    v_cvt_pk_bf16_f32 v40, v32, v33
    v_cvt_pk_bf16_f32 v41, v34, v35
    v_cvt_pk_bf16_f32 v42, v36, v37
    v_cvt_pk_bf16_f32 v43, v38, v39
    s_add_u32 s69, s68, 152576
    buffer_store_dwordx4 v[40:43], v8, s[36:39], s69 offen sc0 sc1
    v_pk_mul_f32 v[16:17], v[200:201], s[64:65]
    v_pk_mul_f32 v[18:19], v[202:203], s[64:65]
    v_pk_mul_f32 v[20:21], v[232:233], s[64:65]
    v_pk_mul_f32 v[22:23], v[234:235], s[64:65]
    v_exp_f32 v16, v16
    v_exp_f32 v17, v17
    v_exp_f32 v18, v18
    v_exp_f32 v19, v19
    v_exp_f32 v20, v20
    v_exp_f32 v21, v21
    v_exp_f32 v22, v22
    v_exp_f32 v23, v23
    v_pk_add_f32 v[16:17], v[16:17], s[66:67]
    v_pk_add_f32 v[18:19], v[18:19], s[66:67]
    v_pk_add_f32 v[20:21], v[20:21], s[66:67]
    v_pk_add_f32 v[22:23], v[22:23], s[66:67]
    v_rcp_f32 v16, v16
    v_rcp_f32 v17, v17
    v_rcp_f32 v18, v18
    v_rcp_f32 v19, v19
    v_rcp_f32 v20, v20
    v_rcp_f32 v21, v21
    v_rcp_f32 v22, v22
    v_rcp_f32 v23, v23
    v_pk_mul_f32 v[16:17], v[16:17], v[216:217]
    v_pk_mul_f32 v[18:19], v[18:19], v[218:219]
    v_pk_mul_f32 v[20:21], v[20:21], v[248:249]
    v_pk_mul_f32 v[22:23], v[22:23], v[250:251]
    v_cvt_pk_bf16_f32 v24, v16, v17
    v_cvt_pk_bf16_f32 v25, v18, v19
    v_cvt_pk_bf16_f32 v26, v20, v21
    v_cvt_pk_bf16_f32 v27, v22, v23
    s_add_u32 s69, s68, 153600
    buffer_store_dwordx4 v[24:27], v8, s[36:39], s69 offen sc0 sc1
    v_pk_mul_f32 v[32:33], v[76:77], s[64:65]
    v_pk_mul_f32 v[34:35], v[78:79], s[64:65]
    v_pk_mul_f32 v[36:37], v[108:109], s[64:65]
    v_pk_mul_f32 v[38:39], v[110:111], s[64:65]
    v_exp_f32 v32, v32
    v_exp_f32 v33, v33
    v_exp_f32 v34, v34
    v_exp_f32 v35, v35
    v_exp_f32 v36, v36
    v_exp_f32 v37, v37
    v_exp_f32 v38, v38
    v_exp_f32 v39, v39
    v_pk_add_f32 v[32:33], v[32:33], s[66:67]
    v_pk_add_f32 v[34:35], v[34:35], s[66:67]
    v_pk_add_f32 v[36:37], v[36:37], s[66:67]
    v_pk_add_f32 v[38:39], v[38:39], s[66:67]
    v_rcp_f32 v32, v32
    v_rcp_f32 v33, v33
    v_rcp_f32 v34, v34
    v_rcp_f32 v35, v35
    v_rcp_f32 v36, v36
    v_rcp_f32 v37, v37
    v_rcp_f32 v38, v38
    v_rcp_f32 v39, v39
    v_pk_mul_f32 v[32:33], v[32:33], v[92:93]
    v_pk_mul_f32 v[34:35], v[34:35], v[94:95]
    v_pk_mul_f32 v[36:37], v[36:37], v[124:125]
    v_pk_mul_f32 v[38:39], v[38:39], v[126:127]
    v_cvt_pk_bf16_f32 v40, v32, v33
    v_cvt_pk_bf16_f32 v41, v34, v35
    v_cvt_pk_bf16_f32 v42, v36, v37
    v_cvt_pk_bf16_f32 v43, v38, v39
    s_add_u32 s69, s68, 227328
    buffer_store_dwordx4 v[40:43], v8, s[36:39], s69 offen sc0 sc1
    v_pk_mul_f32 v[16:17], v[140:141], s[64:65]
    v_pk_mul_f32 v[18:19], v[142:143], s[64:65]
    v_pk_mul_f32 v[20:21], v[172:173], s[64:65]
    v_pk_mul_f32 v[22:23], v[174:175], s[64:65]
    v_exp_f32 v16, v16
    v_exp_f32 v17, v17
    v_exp_f32 v18, v18
    v_exp_f32 v19, v19
    v_exp_f32 v20, v20
    v_exp_f32 v21, v21
    v_exp_f32 v22, v22
    v_exp_f32 v23, v23
    v_pk_add_f32 v[16:17], v[16:17], s[66:67]
    v_pk_add_f32 v[18:19], v[18:19], s[66:67]
    v_pk_add_f32 v[20:21], v[20:21], s[66:67]
    v_pk_add_f32 v[22:23], v[22:23], s[66:67]
    v_rcp_f32 v16, v16
    v_rcp_f32 v17, v17
    v_rcp_f32 v18, v18
    v_rcp_f32 v19, v19
    v_rcp_f32 v20, v20
    v_rcp_f32 v21, v21
    v_rcp_f32 v22, v22
    v_rcp_f32 v23, v23
    v_pk_mul_f32 v[16:17], v[16:17], v[156:157]
    v_pk_mul_f32 v[18:19], v[18:19], v[158:159]
    v_pk_mul_f32 v[20:21], v[20:21], v[188:189]
    v_pk_mul_f32 v[22:23], v[22:23], v[190:191]
    v_cvt_pk_bf16_f32 v24, v16, v17
    v_cvt_pk_bf16_f32 v25, v18, v19
    v_cvt_pk_bf16_f32 v26, v20, v21
    v_cvt_pk_bf16_f32 v27, v22, v23
    s_add_u32 s69, s68, 228352
    buffer_store_dwordx4 v[24:27], v8, s[36:39], s69 offen sc0 sc1
    v_pk_mul_f32 v[32:33], v[204:205], s[64:65]
    v_pk_mul_f32 v[34:35], v[206:207], s[64:65]
    v_pk_mul_f32 v[36:37], v[236:237], s[64:65]
    v_pk_mul_f32 v[38:39], v[238:239], s[64:65]
    v_exp_f32 v32, v32
    v_exp_f32 v33, v33
    v_exp_f32 v34, v34
    v_exp_f32 v35, v35
    v_exp_f32 v36, v36
    v_exp_f32 v37, v37
    v_exp_f32 v38, v38
    v_exp_f32 v39, v39
    v_pk_add_f32 v[32:33], v[32:33], s[66:67]
    v_pk_add_f32 v[34:35], v[34:35], s[66:67]
    v_pk_add_f32 v[36:37], v[36:37], s[66:67]
    v_pk_add_f32 v[38:39], v[38:39], s[66:67]
    v_rcp_f32 v32, v32
    v_rcp_f32 v33, v33
    v_rcp_f32 v34, v34
    v_rcp_f32 v35, v35
    v_rcp_f32 v36, v36
    v_rcp_f32 v37, v37
    v_rcp_f32 v38, v38
    v_rcp_f32 v39, v39
    v_pk_mul_f32 v[32:33], v[32:33], v[220:221]
    v_pk_mul_f32 v[34:35], v[34:35], v[222:223]
    v_pk_mul_f32 v[36:37], v[36:37], v[252:253]
    v_pk_mul_f32 v[38:39], v[38:39], v[254:255]
    v_cvt_pk_bf16_f32 v40, v32, v33
    v_cvt_pk_bf16_f32 v41, v34, v35
    v_cvt_pk_bf16_f32 v42, v36, v37
    v_cvt_pk_bf16_f32 v43, v38, v39
    s_add_u32 s69, s68, 229376
    buffer_store_dwordx4 v[40:43], v8, s[36:39], s69 offen sc0 sc1
    s_endpgm
K1_Q:
    v_lshlrev_b32 v14, 4, v9
    v_add_u32 v14, 147456, v14
    s_barrier
    ds_read_b128 v[16:19], v2 offset:0
    ds_read_b128 v[20:23], v2 offset:2048
    ds_read_b128 v[24:27], v2 offset:4096
    ds_read_b128 v[28:31], v2 offset:6144
    ds_read_b128 v[240:243], v14 offset:0
    ds_read_b64_tr_b16 v[48:49], v4 offset:0
    ds_read_b64_tr_b16 v[50:51], v4 offset:1536
    ds_read_b64_tr_b16 v[52:53], v5 offset:0
    ds_read_b64_tr_b16 v[54:55], v5 offset:1536
    ds_read_b64_tr_b16 v[56:57], v6 offset:0
    ds_read_b64_tr_b16 v[58:59], v6 offset:1536
K1_LOOP_q:
    buffer_load_dword v13, v12, s[32:35], s78 offen
    s_add_u32 s78, s78, s79
    s_waitcnt lgkmcnt(4)
    v_mfma_f32_16x16x32_bf16 v[64:67], v[48:51], v[16:19], v[64:67]
    ds_read_b64_tr_b16 v[60:61], v7 offset:0
    v_mfma_f32_16x16x32_bf16 v[68:71], v[48:51], v[20:23], v[68:71]
    ds_read_b64_tr_b16 v[62:63], v7 offset:1536
    v_mfma_f32_16x16x32_bf16 v[72:75], v[48:51], v[24:27], v[72:75]
    v_mfma_f32_16x16x32_bf16 v[76:79], v[48:51], v[28:31], v[76:79]
    s_waitcnt lgkmcnt(4)
    v_mfma_f32_16x16x32_bf16 v[80:83], v[52:55], v[16:19], v[80:83]
    ds_read_b64_tr_b16 v[48:49], v4 offset:128
    v_mfma_f32_16x16x32_bf16 v[84:87], v[52:55], v[20:23], v[84:87]
    ds_read_b64_tr_b16 v[50:51], v4 offset:1664
    v_mfma_f32_16x16x32_bf16 v[88:91], v[52:55], v[24:27], v[88:91]
    v_mfma_f32_16x16x32_bf16 v[92:95], v[52:55], v[28:31], v[92:95]
    s_waitcnt lgkmcnt(4)
    v_mfma_f32_16x16x32_bf16 v[96:99], v[56:59], v[16:19], v[96:99]
    ds_read_b64_tr_b16 v[52:53], v5 offset:128
    v_mfma_f32_16x16x32_bf16 v[100:103], v[56:59], v[20:23], v[100:103]
    ds_read_b64_tr_b16 v[54:55], v5 offset:1664
    v_mfma_f32_16x16x32_bf16 v[104:107], v[56:59], v[24:27], v[104:107]
    v_mfma_f32_16x16x32_bf16 v[108:111], v[56:59], v[28:31], v[108:111]
    s_waitcnt lgkmcnt(4)
    v_mfma_f32_16x16x32_bf16 v[112:115], v[60:63], v[16:19], v[112:115]
    ds_read_b64_tr_b16 v[56:57], v6 offset:128
    v_mfma_f32_16x16x32_bf16 v[116:119], v[60:63], v[20:23], v[116:119]
    ds_read_b64_tr_b16 v[58:59], v6 offset:1664
    v_mfma_f32_16x16x32_bf16 v[120:123], v[60:63], v[24:27], v[120:123]
    v_mfma_f32_16x16x32_bf16 v[124:127], v[60:63], v[28:31], v[124:127]
    s_waitcnt lgkmcnt(4)
    v_mfma_f32_16x16x32_bf16 v[128:131], v[48:51], v[16:19], v[128:131]
    ds_read_b64_tr_b16 v[60:61], v7 offset:128
    v_mfma_f32_16x16x32_bf16 v[132:135], v[48:51], v[20:23], v[132:135]
    ds_read_b64_tr_b16 v[62:63], v7 offset:1664
    v_mfma_f32_16x16x32_bf16 v[136:139], v[48:51], v[24:27], v[136:139]
    v_mfma_f32_16x16x32_bf16 v[140:143], v[48:51], v[28:31], v[140:143]
    s_waitcnt lgkmcnt(4)
    v_mfma_f32_16x16x32_bf16 v[144:147], v[52:55], v[16:19], v[144:147]
    ds_read_b64_tr_b16 v[48:49], v4 offset:256
    v_mfma_f32_16x16x32_bf16 v[148:151], v[52:55], v[20:23], v[148:151]
    ds_read_b64_tr_b16 v[50:51], v4 offset:1792
    v_mfma_f32_16x16x32_bf16 v[152:155], v[52:55], v[24:27], v[152:155]
    v_mfma_f32_16x16x32_bf16 v[156:159], v[52:55], v[28:31], v[156:159]
    s_waitcnt lgkmcnt(4)
    v_mfma_f32_16x16x32_bf16 v[160:163], v[56:59], v[16:19], v[160:163]
    ds_read_b64_tr_b16 v[52:53], v5 offset:256
    v_mfma_f32_16x16x32_bf16 v[164:167], v[56:59], v[20:23], v[164:167]
    ds_read_b64_tr_b16 v[54:55], v5 offset:1792
    v_mfma_f32_16x16x32_bf16 v[168:171], v[56:59], v[24:27], v[168:171]
    v_mfma_f32_16x16x32_bf16 v[172:175], v[56:59], v[28:31], v[172:175]
    s_waitcnt lgkmcnt(4)
    v_mfma_f32_16x16x32_bf16 v[176:179], v[60:63], v[16:19], v[176:179]
    v_mfma_f32_16x16x32_bf16 v[180:183], v[60:63], v[20:23], v[180:183]
    v_mfma_f32_16x16x32_bf16 v[184:187], v[60:63], v[24:27], v[184:187]
    v_mfma_f32_16x16x32_bf16 v[188:191], v[60:63], v[28:31], v[188:191]
    v_mfma_f32_16x16x32_bf16 v[224:227], v[240:243], v[16:19], v[224:227]
    v_mfma_f32_16x16x32_bf16 v[228:231], v[240:243], v[20:23], v[228:231]
    v_mfma_f32_16x16x32_bf16 v[232:235], v[240:243], v[24:27], v[232:235]
    v_mfma_f32_16x16x32_bf16 v[236:239], v[240:243], v[28:31], v[236:239]
    s_waitcnt lgkmcnt(0)
    s_barrier
    v_mfma_f32_16x16x32_bf16 v[192:195], v[48:51], v[16:19], v[192:195]
    ds_read_b128 v[32:35], v3 offset:0
    ds_read_b128 v[36:39], v3 offset:2048
    ds_read_b128 v[40:43], v3 offset:4096
    v_mfma_f32_16x16x32_bf16 v[196:199], v[48:51], v[20:23], v[196:199]
    ds_read_b128 v[44:47], v3 offset:6144
    ds_read_b128 v[244:247], v14 offset:64
    v_mfma_f32_16x16x32_bf16 v[200:203], v[48:51], v[24:27], v[200:203]
    ds_read_b64_tr_b16 v[56:57], v4 offset:24576
    ds_read_b64_tr_b16 v[58:59], v4 offset:26112
    v_mfma_f32_16x16x32_bf16 v[204:207], v[48:51], v[28:31], v[204:207]
    ds_read_b64_tr_b16 v[60:61], v5 offset:24576
    ds_read_b64_tr_b16 v[62:63], v5 offset:26112
    v_mfma_f32_16x16x32_bf16 v[208:211], v[52:55], v[16:19], v[208:211]
    ds_read_b64_tr_b16 v[48:49], v6 offset:24576
    v_mfma_f32_16x16x32_bf16 v[212:215], v[52:55], v[20:23], v[212:215]
    ds_read_b64_tr_b16 v[50:51], v6 offset:26112
    v_mfma_f32_16x16x32_bf16 v[216:219], v[52:55], v[24:27], v[216:219]
    v_mfma_f32_16x16x32_bf16 v[220:223], v[52:55], v[28:31], v[220:223]
    s_waitcnt lgkmcnt(4)
    v_mfma_f32_16x16x32_bf16 v[64:67], v[56:59], v[32:35], v[64:67]
    ds_read_b64_tr_b16 v[52:53], v7 offset:24576
    v_mfma_f32_16x16x32_bf16 v[68:71], v[56:59], v[36:39], v[68:71]
    ds_read_b64_tr_b16 v[54:55], v7 offset:26112
    v_mfma_f32_16x16x32_bf16 v[72:75], v[56:59], v[40:43], v[72:75]
    v_mfma_f32_16x16x32_bf16 v[76:79], v[56:59], v[44:47], v[76:79]
    s_waitcnt lgkmcnt(4)
    v_mfma_f32_16x16x32_bf16 v[80:83], v[60:63], v[32:35], v[80:83]
    ds_read_b64_tr_b16 v[56:57], v4 offset:24704
    v_mfma_f32_16x16x32_bf16 v[84:87], v[60:63], v[36:39], v[84:87]
    ds_read_b64_tr_b16 v[58:59], v4 offset:26240
    v_mfma_f32_16x16x32_bf16 v[88:91], v[60:63], v[40:43], v[88:91]
    v_mfma_f32_16x16x32_bf16 v[92:95], v[60:63], v[44:47], v[92:95]
    s_waitcnt lgkmcnt(4)
    v_mfma_f32_16x16x32_bf16 v[96:99], v[48:51], v[32:35], v[96:99]
    ds_read_b64_tr_b16 v[60:61], v5 offset:24704
    v_mfma_f32_16x16x32_bf16 v[100:103], v[48:51], v[36:39], v[100:103]
    ds_read_b64_tr_b16 v[62:63], v5 offset:26240
    v_mfma_f32_16x16x32_bf16 v[104:107], v[48:51], v[40:43], v[104:107]
    v_mfma_f32_16x16x32_bf16 v[108:111], v[48:51], v[44:47], v[108:111]
    s_waitcnt lgkmcnt(4)
    v_mfma_f32_16x16x32_bf16 v[112:115], v[52:55], v[32:35], v[112:115]
    ds_read_b64_tr_b16 v[48:49], v6 offset:24704
    v_mfma_f32_16x16x32_bf16 v[116:119], v[52:55], v[36:39], v[116:119]
    ds_read_b64_tr_b16 v[50:51], v6 offset:26240
    v_mfma_f32_16x16x32_bf16 v[120:123], v[52:55], v[40:43], v[120:123]
    v_mfma_f32_16x16x32_bf16 v[124:127], v[52:55], v[44:47], v[124:127]
    s_waitcnt lgkmcnt(4)
    v_mfma_f32_16x16x32_bf16 v[128:131], v[56:59], v[32:35], v[128:131]
    ds_read_b64_tr_b16 v[52:53], v7 offset:24704
    v_mfma_f32_16x16x32_bf16 v[132:135], v[56:59], v[36:39], v[132:135]
    ds_read_b64_tr_b16 v[54:55], v7 offset:26240
    v_mfma_f32_16x16x32_bf16 v[136:139], v[56:59], v[40:43], v[136:139]
    v_mfma_f32_16x16x32_bf16 v[140:143], v[56:59], v[44:47], v[140:143]
    s_waitcnt lgkmcnt(4)
    v_mfma_f32_16x16x32_bf16 v[144:147], v[60:63], v[32:35], v[144:147]
    ds_read_b64_tr_b16 v[56:57], v4 offset:24832
    v_mfma_f32_16x16x32_bf16 v[148:151], v[60:63], v[36:39], v[148:151]
    ds_read_b64_tr_b16 v[58:59], v4 offset:26368
    v_mfma_f32_16x16x32_bf16 v[152:155], v[60:63], v[40:43], v[152:155]
    v_mfma_f32_16x16x32_bf16 v[156:159], v[60:63], v[44:47], v[156:159]
    s_waitcnt lgkmcnt(4)
    v_mfma_f32_16x16x32_bf16 v[160:163], v[48:51], v[32:35], v[160:163]
    ds_read_b64_tr_b16 v[60:61], v5 offset:24832
    v_mfma_f32_16x16x32_bf16 v[164:167], v[48:51], v[36:39], v[164:167]
    ds_read_b64_tr_b16 v[62:63], v5 offset:26368
    v_mfma_f32_16x16x32_bf16 v[168:171], v[48:51], v[40:43], v[168:171]
    v_mfma_f32_16x16x32_bf16 v[172:175], v[48:51], v[44:47], v[172:175]
    s_waitcnt lgkmcnt(4)
    v_mfma_f32_16x16x32_bf16 v[176:179], v[52:55], v[32:35], v[176:179]
    v_mfma_f32_16x16x32_bf16 v[180:183], v[52:55], v[36:39], v[180:183]
    v_mfma_f32_16x16x32_bf16 v[184:187], v[52:55], v[40:43], v[184:187]
    v_mfma_f32_16x16x32_bf16 v[188:191], v[52:55], v[44:47], v[188:191]
    v_mfma_f32_16x16x32_bf16 v[224:227], v[244:247], v[32:35], v[224:227]
    v_mfma_f32_16x16x32_bf16 v[228:231], v[244:247], v[36:39], v[228:231]
    v_mfma_f32_16x16x32_bf16 v[232:235], v[244:247], v[40:43], v[232:235]
    v_mfma_f32_16x16x32_bf16 v[236:239], v[244:247], v[44:47], v[236:239]
    s_waitcnt lgkmcnt(0)
    s_barrier
    v_add_u32 v4, s75, v4
    v_add_u32 v5, s75, v5
    v_add_u32 v6, s75, v6
    v_add_u32 v7, s75, v7
    s_sub_u32 s75, 0, s75
    s_add_u32 s70, s70, 16384
    s_cmp_eq_u32 s70, 49152
    s_cselect_b32 s73, s70, 0
    s_sub_u32 s70, s70, s73
    s_sub_u32 s73, 16384, s73
    v_add_u32 v2, s73, v2
    v_add_u32 v3, s73, v3
    v_add_u32 v14, 128, v14
    v_mfma_f32_16x16x32_bf16 v[192:195], v[56:59], v[32:35], v[192:195]
    ds_read_b128 v[16:19], v2 offset:0
    ds_read_b128 v[20:23], v2 offset:2048
    ds_read_b128 v[24:27], v2 offset:4096
    v_mfma_f32_16x16x32_bf16 v[196:199], v[56:59], v[36:39], v[196:199]
    ds_read_b128 v[28:31], v2 offset:6144
    ds_read_b128 v[240:243], v14 offset:0
    v_mfma_f32_16x16x32_bf16 v[200:203], v[56:59], v[40:43], v[200:203]
    ds_read_b64_tr_b16 v[48:49], v4 offset:0
    ds_read_b64_tr_b16 v[50:51], v4 offset:1536
    v_mfma_f32_16x16x32_bf16 v[204:207], v[56:59], v[44:47], v[204:207]
    ds_read_b64_tr_b16 v[52:53], v5 offset:0
    ds_read_b64_tr_b16 v[54:55], v5 offset:1536
    v_mfma_f32_16x16x32_bf16 v[208:211], v[60:63], v[32:35], v[208:211]
    ds_read_b64_tr_b16 v[56:57], v6 offset:0
    v_mfma_f32_16x16x32_bf16 v[212:215], v[60:63], v[36:39], v[212:215]
    ds_read_b64_tr_b16 v[58:59], v6 offset:1536
    v_mfma_f32_16x16x32_bf16 v[216:219], v[60:63], v[40:43], v[216:219]
    v_mfma_f32_16x16x32_bf16 v[220:223], v[60:63], v[44:47], v[220:223]
    s_sub_u32 s71, s71, 1
    s_cmp_lg_u32 s71, 0
    s_cbranch_scc1 K1_LOOP_q
    s_waitcnt lgkmcnt(0) vmcnt(0)
    s_nop 7
    s_mov_b32 s64, 0x3fb8aa3b
    s_mov_b32 s65, 0x3fb8aa3b
    s_mov_b32 s66, 0x358637bd
    s_mov_b32 s67, 0x358637bd
    s_lshl_b32 s68, s42, 3
    s_lshl_b32 s69, s44, 2
    s_add_u32 s68, s68, s69
    s_lshl_b32 s74, s68, 6
    s_mul_i32 s68, s68, 74
    s_sub_u32 s69, s43, 13
    s_mul_i32 s69, s69, 10
    s_add_u32 s68, s68, s69
    s_mul_i32 s69, s45, 5
    s_add_u32 s68, s68, s69
    s_add_u32 s68, s68, 54
    s_lshl_b32 s68, s68, 10
    v_lshlrev_b32 v8, 4, v1
    v_pk_mul_f32 v[16:17], v[64:65], s[64:65]
    v_pk_mul_f32 v[18:19], v[66:67], s[64:65]
    v_pk_mul_f32 v[20:21], v[80:81], s[64:65]
    v_pk_mul_f32 v[22:23], v[82:83], s[64:65]
    v_exp_f32 v16, v16 clamp
    v_exp_f32 v17, v17 clamp
    v_exp_f32 v18, v18 clamp
    v_exp_f32 v19, v19 clamp
    v_exp_f32 v20, v20 clamp
    v_exp_f32 v21, v21 clamp
    v_exp_f32 v22, v22 clamp
    v_exp_f32 v23, v23 clamp
    v_max_f32 v24, 0, v64
    v_max_f32 v25, 0, v65
    v_max_f32 v26, 0, v66
    v_max_f32 v27, 0, v67
    v_max_f32 v28, 0, v80
    v_max_f32 v29, 0, v81
    v_max_f32 v30, 0, v82
    v_max_f32 v31, 0, v83
    v_pk_add_f32 v[16:17], v[16:17], v[24:25]
    v_pk_add_f32 v[18:19], v[18:19], v[26:27]
    v_pk_add_f32 v[20:21], v[20:21], v[28:29]
    v_pk_add_f32 v[22:23], v[22:23], v[30:31]
    v_pk_add_f32 v[16:17], v[16:17], s[66:67]
    v_pk_add_f32 v[18:19], v[18:19], s[66:67]
    v_pk_add_f32 v[20:21], v[20:21], s[66:67]
    v_pk_add_f32 v[22:23], v[22:23], s[66:67]
    v_cvt_pk_bf16_f32 v32, v16, v17
    v_cvt_pk_bf16_f32 v33, v18, v19
    v_cvt_pk_bf16_f32 v34, v20, v21
    v_cvt_pk_bf16_f32 v35, v22, v23
    s_add_u32 s69, s68, 0
    buffer_store_dwordx4 v[32:35], v8, s[36:39], s69 offen sc0 sc1
    v_pk_mul_f32 v[36:37], v[96:97], s[64:65]
    v_pk_mul_f32 v[38:39], v[98:99], s[64:65]
    v_pk_mul_f32 v[40:41], v[112:113], s[64:65]
    v_pk_mul_f32 v[42:43], v[114:115], s[64:65]
    v_exp_f32 v36, v36 clamp
    v_exp_f32 v37, v37 clamp
    v_exp_f32 v38, v38 clamp
    v_exp_f32 v39, v39 clamp
    v_exp_f32 v40, v40 clamp
    v_exp_f32 v41, v41 clamp
    v_exp_f32 v42, v42 clamp
    v_exp_f32 v43, v43 clamp
    v_max_f32 v44, 0, v96
    v_max_f32 v45, 0, v97
    v_max_f32 v46, 0, v98
    v_max_f32 v47, 0, v99
    v_max_f32 v48, 0, v112
    v_max_f32 v49, 0, v113
    v_max_f32 v50, 0, v114
    v_max_f32 v51, 0, v115
    v_pk_add_f32 v[36:37], v[36:37], v[44:45]
    v_pk_add_f32 v[38:39], v[38:39], v[46:47]
    v_pk_add_f32 v[40:41], v[40:41], v[48:49]
    v_pk_add_f32 v[42:43], v[42:43], v[50:51]
    v_pk_add_f32 v[36:37], v[36:37], s[66:67]
    v_pk_add_f32 v[38:39], v[38:39], s[66:67]
    v_pk_add_f32 v[40:41], v[40:41], s[66:67]
    v_pk_add_f32 v[42:43], v[42:43], s[66:67]
    v_cvt_pk_bf16_f32 v52, v36, v37
    v_cvt_pk_bf16_f32 v53, v38, v39
    v_cvt_pk_bf16_f32 v54, v40, v41
    v_cvt_pk_bf16_f32 v55, v42, v43
    s_add_u32 s69, s68, 1024
    buffer_store_dwordx4 v[52:55], v8, s[36:39], s69 offen sc0 sc1
    v_pk_mul_f32 v[16:17], v[128:129], s[64:65]
    v_pk_mul_f32 v[18:19], v[130:131], s[64:65]
    v_pk_mul_f32 v[20:21], v[144:145], s[64:65]
    v_pk_mul_f32 v[22:23], v[146:147], s[64:65]
    v_exp_f32 v16, v16 clamp
    v_exp_f32 v17, v17 clamp
    v_exp_f32 v18, v18 clamp
    v_exp_f32 v19, v19 clamp
    v_exp_f32 v20, v20 clamp
    v_exp_f32 v21, v21 clamp
    v_exp_f32 v22, v22 clamp
    v_exp_f32 v23, v23 clamp
    v_max_f32 v24, 0, v128
    v_max_f32 v25, 0, v129
    v_max_f32 v26, 0, v130
    v_max_f32 v27, 0, v131
    v_max_f32 v28, 0, v144
    v_max_f32 v29, 0, v145
    v_max_f32 v30, 0, v146
    v_max_f32 v31, 0, v147
    v_pk_add_f32 v[16:17], v[16:17], v[24:25]
    v_pk_add_f32 v[18:19], v[18:19], v[26:27]
    v_pk_add_f32 v[20:21], v[20:21], v[28:29]
    v_pk_add_f32 v[22:23], v[22:23], v[30:31]
    v_pk_add_f32 v[16:17], v[16:17], s[66:67]
    v_pk_add_f32 v[18:19], v[18:19], s[66:67]
    v_pk_add_f32 v[20:21], v[20:21], s[66:67]
    v_pk_add_f32 v[22:23], v[22:23], s[66:67]
    v_cvt_pk_bf16_f32 v32, v16, v17
    v_cvt_pk_bf16_f32 v33, v18, v19
    v_cvt_pk_bf16_f32 v34, v20, v21
    v_cvt_pk_bf16_f32 v35, v22, v23
    s_add_u32 s69, s68, 2048
    buffer_store_dwordx4 v[32:35], v8, s[36:39], s69 offen sc0 sc1
    v_pk_mul_f32 v[36:37], v[160:161], s[64:65]
    v_pk_mul_f32 v[38:39], v[162:163], s[64:65]
    v_pk_mul_f32 v[40:41], v[176:177], s[64:65]
    v_pk_mul_f32 v[42:43], v[178:179], s[64:65]
    v_exp_f32 v36, v36 clamp
    v_exp_f32 v37, v37 clamp
    v_exp_f32 v38, v38 clamp
    v_exp_f32 v39, v39 clamp
    v_exp_f32 v40, v40 clamp
    v_exp_f32 v41, v41 clamp
    v_exp_f32 v42, v42 clamp
    v_exp_f32 v43, v43 clamp
    v_max_f32 v44, 0, v160
    v_max_f32 v45, 0, v161
    v_max_f32 v46, 0, v162
    v_max_f32 v47, 0, v163
    v_max_f32 v48, 0, v176
    v_max_f32 v49, 0, v177
    v_max_f32 v50, 0, v178
    v_max_f32 v51, 0, v179
    v_pk_add_f32 v[36:37], v[36:37], v[44:45]
    v_pk_add_f32 v[38:39], v[38:39], v[46:47]
    v_pk_add_f32 v[40:41], v[40:41], v[48:49]
    v_pk_add_f32 v[42:43], v[42:43], v[50:51]
    v_pk_add_f32 v[36:37], v[36:37], s[66:67]
    v_pk_add_f32 v[38:39], v[38:39], s[66:67]
    v_pk_add_f32 v[40:41], v[40:41], s[66:67]
    v_pk_add_f32 v[42:43], v[42:43], s[66:67]
    v_cvt_pk_bf16_f32 v52, v36, v37
    v_cvt_pk_bf16_f32 v53, v38, v39
    v_cvt_pk_bf16_f32 v54, v40, v41
    v_cvt_pk_bf16_f32 v55, v42, v43
    s_add_u32 s69, s68, 3072
    buffer_store_dwordx4 v[52:55], v8, s[36:39], s69 offen sc0 sc1
    v_pk_mul_f32 v[16:17], v[192:193], s[64:65]
    v_pk_mul_f32 v[18:19], v[194:195], s[64:65]
    v_pk_mul_f32 v[20:21], v[208:209], s[64:65]
    v_pk_mul_f32 v[22:23], v[210:211], s[64:65]
    v_exp_f32 v16, v16 clamp
    v_exp_f32 v17, v17 clamp
    v_exp_f32 v18, v18 clamp
    v_exp_f32 v19, v19 clamp
    v_exp_f32 v20, v20 clamp
    v_exp_f32 v21, v21 clamp
    v_exp_f32 v22, v22 clamp
    v_exp_f32 v23, v23 clamp
    v_max_f32 v24, 0, v192
    v_max_f32 v25, 0, v193
    v_max_f32 v26, 0, v194
    v_max_f32 v27, 0, v195
    v_max_f32 v28, 0, v208
    v_max_f32 v29, 0, v209
    v_max_f32 v30, 0, v210
    v_max_f32 v31, 0, v211
    v_pk_add_f32 v[16:17], v[16:17], v[24:25]
    v_pk_add_f32 v[18:19], v[18:19], v[26:27]
    v_pk_add_f32 v[20:21], v[20:21], v[28:29]
    v_pk_add_f32 v[22:23], v[22:23], v[30:31]
    v_pk_add_f32 v[16:17], v[16:17], s[66:67]
    v_pk_add_f32 v[18:19], v[18:19], s[66:67]
    v_pk_add_f32 v[20:21], v[20:21], s[66:67]
    v_pk_add_f32 v[22:23], v[22:23], s[66:67]
    v_cvt_pk_bf16_f32 v32, v16, v17
    v_cvt_pk_bf16_f32 v33, v18, v19
    v_cvt_pk_bf16_f32 v34, v20, v21
    v_cvt_pk_bf16_f32 v35, v22, v23
    s_add_u32 s69, s68, 4096
    buffer_store_dwordx4 v[32:35], v8, s[36:39], s69 offen sc0 sc1
    v_pk_mul_f32 v[36:37], v[68:69], s[64:65]
    v_pk_mul_f32 v[38:39], v[70:71], s[64:65]
    v_pk_mul_f32 v[40:41], v[84:85], s[64:65]
    v_pk_mul_f32 v[42:43], v[86:87], s[64:65]
    v_exp_f32 v36, v36 clamp
    v_exp_f32 v37, v37 clamp
    v_exp_f32 v38, v38 clamp
    v_exp_f32 v39, v39 clamp
    v_exp_f32 v40, v40 clamp
    v_exp_f32 v41, v41 clamp
    v_exp_f32 v42, v42 clamp
    v_exp_f32 v43, v43 clamp
    v_max_f32 v44, 0, v68
    v_max_f32 v45, 0, v69
    v_max_f32 v46, 0, v70
    v_max_f32 v47, 0, v71
    v_max_f32 v48, 0, v84
    v_max_f32 v49, 0, v85
    v_max_f32 v50, 0, v86
    v_max_f32 v51, 0, v87
    v_pk_add_f32 v[36:37], v[36:37], v[44:45]
    v_pk_add_f32 v[38:39], v[38:39], v[46:47]
    v_pk_add_f32 v[40:41], v[40:41], v[48:49]
    v_pk_add_f32 v[42:43], v[42:43], v[50:51]
    v_pk_add_f32 v[36:37], v[36:37], s[66:67]
    v_pk_add_f32 v[38:39], v[38:39], s[66:67]
    v_pk_add_f32 v[40:41], v[40:41], s[66:67]
    v_pk_add_f32 v[42:43], v[42:43], s[66:67]
    v_cvt_pk_bf16_f32 v52, v36, v37
    v_cvt_pk_bf16_f32 v53, v38, v39
    v_cvt_pk_bf16_f32 v54, v40, v41
    v_cvt_pk_bf16_f32 v55, v42, v43
    s_add_u32 s69, s68, 75776
    buffer_store_dwordx4 v[52:55], v8, s[36:39], s69 offen sc0 sc1
    v_pk_mul_f32 v[16:17], v[100:101], s[64:65]
    v_pk_mul_f32 v[18:19], v[102:103], s[64:65]
    v_pk_mul_f32 v[20:21], v[116:117], s[64:65]
    v_pk_mul_f32 v[22:23], v[118:119], s[64:65]
    v_exp_f32 v16, v16 clamp
    v_exp_f32 v17, v17 clamp
    v_exp_f32 v18, v18 clamp
    v_exp_f32 v19, v19 clamp
    v_exp_f32 v20, v20 clamp
    v_exp_f32 v21, v21 clamp
    v_exp_f32 v22, v22 clamp
    v_exp_f32 v23, v23 clamp
    v_max_f32 v24, 0, v100
    v_max_f32 v25, 0, v101
    v_max_f32 v26, 0, v102
    v_max_f32 v27, 0, v103
    v_max_f32 v28, 0, v116
    v_max_f32 v29, 0, v117
    v_max_f32 v30, 0, v118
    v_max_f32 v31, 0, v119
    v_pk_add_f32 v[16:17], v[16:17], v[24:25]
    v_pk_add_f32 v[18:19], v[18:19], v[26:27]
    v_pk_add_f32 v[20:21], v[20:21], v[28:29]
    v_pk_add_f32 v[22:23], v[22:23], v[30:31]
    v_pk_add_f32 v[16:17], v[16:17], s[66:67]
    v_pk_add_f32 v[18:19], v[18:19], s[66:67]
    v_pk_add_f32 v[20:21], v[20:21], s[66:67]
    v_pk_add_f32 v[22:23], v[22:23], s[66:67]
    v_cvt_pk_bf16_f32 v32, v16, v17
    v_cvt_pk_bf16_f32 v33, v18, v19
    v_cvt_pk_bf16_f32 v34, v20, v21
    v_cvt_pk_bf16_f32 v35, v22, v23
    s_add_u32 s69, s68, 76800
    buffer_store_dwordx4 v[32:35], v8, s[36:39], s69 offen sc0 sc1
    v_pk_mul_f32 v[36:37], v[132:133], s[64:65]
    v_pk_mul_f32 v[38:39], v[134:135], s[64:65]
    v_pk_mul_f32 v[40:41], v[148:149], s[64:65]
    v_pk_mul_f32 v[42:43], v[150:151], s[64:65]
    v_exp_f32 v36, v36 clamp
    v_exp_f32 v37, v37 clamp
    v_exp_f32 v38, v38 clamp
    v_exp_f32 v39, v39 clamp
    v_exp_f32 v40, v40 clamp
    v_exp_f32 v41, v41 clamp
    v_exp_f32 v42, v42 clamp
    v_exp_f32 v43, v43 clamp
    v_max_f32 v44, 0, v132
    v_max_f32 v45, 0, v133
    v_max_f32 v46, 0, v134
    v_max_f32 v47, 0, v135
    v_max_f32 v48, 0, v148
    v_max_f32 v49, 0, v149
    v_max_f32 v50, 0, v150
    v_max_f32 v51, 0, v151
    v_pk_add_f32 v[36:37], v[36:37], v[44:45]
    v_pk_add_f32 v[38:39], v[38:39], v[46:47]
    v_pk_add_f32 v[40:41], v[40:41], v[48:49]
    v_pk_add_f32 v[42:43], v[42:43], v[50:51]
    v_pk_add_f32 v[36:37], v[36:37], s[66:67]
    v_pk_add_f32 v[38:39], v[38:39], s[66:67]
    v_pk_add_f32 v[40:41], v[40:41], s[66:67]
    v_pk_add_f32 v[42:43], v[42:43], s[66:67]
    v_cvt_pk_bf16_f32 v52, v36, v37
    v_cvt_pk_bf16_f32 v53, v38, v39
    v_cvt_pk_bf16_f32 v54, v40, v41
    v_cvt_pk_bf16_f32 v55, v42, v43
    s_add_u32 s69, s68, 77824
    buffer_store_dwordx4 v[52:55], v8, s[36:39], s69 offen sc0 sc1
    v_pk_mul_f32 v[16:17], v[164:165], s[64:65]
    v_pk_mul_f32 v[18:19], v[166:167], s[64:65]
    v_pk_mul_f32 v[20:21], v[180:181], s[64:65]
    v_pk_mul_f32 v[22:23], v[182:183], s[64:65]
    v_exp_f32 v16, v16 clamp
    v_exp_f32 v17, v17 clamp
    v_exp_f32 v18, v18 clamp
    v_exp_f32 v19, v19 clamp
    v_exp_f32 v20, v20 clamp
    v_exp_f32 v21, v21 clamp
    v_exp_f32 v22, v22 clamp
    v_exp_f32 v23, v23 clamp
    v_max_f32 v24, 0, v164
    v_max_f32 v25, 0, v165
    v_max_f32 v26, 0, v166
    v_max_f32 v27, 0, v167
    v_max_f32 v28, 0, v180
    v_max_f32 v29, 0, v181
    v_max_f32 v30, 0, v182
    v_max_f32 v31, 0, v183
    v_pk_add_f32 v[16:17], v[16:17], v[24:25]
    v_pk_add_f32 v[18:19], v[18:19], v[26:27]
    v_pk_add_f32 v[20:21], v[20:21], v[28:29]
    v_pk_add_f32 v[22:23], v[22:23], v[30:31]
    v_pk_add_f32 v[16:17], v[16:17], s[66:67]
    v_pk_add_f32 v[18:19], v[18:19], s[66:67]
    v_pk_add_f32 v[20:21], v[20:21], s[66:67]
    v_pk_add_f32 v[22:23], v[22:23], s[66:67]
    v_cvt_pk_bf16_f32 v32, v16, v17
    v_cvt_pk_bf16_f32 v33, v18, v19
    v_cvt_pk_bf16_f32 v34, v20, v21
    v_cvt_pk_bf16_f32 v35, v22, v23
    s_add_u32 s69, s68, 78848
    buffer_store_dwordx4 v[32:35], v8, s[36:39], s69 offen sc0 sc1
    v_pk_mul_f32 v[36:37], v[196:197], s[64:65]
    v_pk_mul_f32 v[38:39], v[198:199], s[64:65]
    v_pk_mul_f32 v[40:41], v[212:213], s[64:65]
    v_pk_mul_f32 v[42:43], v[214:215], s[64:65]
    v_exp_f32 v36, v36 clamp
    v_exp_f32 v37, v37 clamp
    v_exp_f32 v38, v38 clamp
    v_exp_f32 v39, v39 clamp
    v_exp_f32 v40, v40 clamp
    v_exp_f32 v41, v41 clamp
    v_exp_f32 v42, v42 clamp
    v_exp_f32 v43, v43 clamp
    v_max_f32 v44, 0, v196
    v_max_f32 v45, 0, v197
    v_max_f32 v46, 0, v198
    v_max_f32 v47, 0, v199
    v_max_f32 v48, 0, v212
    v_max_f32 v49, 0, v213
    v_max_f32 v50, 0, v214
    v_max_f32 v51, 0, v215
    v_pk_add_f32 v[36:37], v[36:37], v[44:45]
    v_pk_add_f32 v[38:39], v[38:39], v[46:47]
    v_pk_add_f32 v[40:41], v[40:41], v[48:49]
    v_pk_add_f32 v[42:43], v[42:43], v[50:51]
    v_pk_add_f32 v[36:37], v[36:37], s[66:67]
    v_pk_add_f32 v[38:39], v[38:39], s[66:67]
    v_pk_add_f32 v[40:41], v[40:41], s[66:67]
    v_pk_add_f32 v[42:43], v[42:43], s[66:67]
    v_cvt_pk_bf16_f32 v52, v36, v37
    v_cvt_pk_bf16_f32 v53, v38, v39
    v_cvt_pk_bf16_f32 v54, v40, v41
    v_cvt_pk_bf16_f32 v55, v42, v43
    s_add_u32 s69, s68, 79872
    buffer_store_dwordx4 v[52:55], v8, s[36:39], s69 offen sc0 sc1
    v_pk_mul_f32 v[16:17], v[72:73], s[64:65]
    v_pk_mul_f32 v[18:19], v[74:75], s[64:65]
    v_pk_mul_f32 v[20:21], v[88:89], s[64:65]
    v_pk_mul_f32 v[22:23], v[90:91], s[64:65]
    v_exp_f32 v16, v16 clamp
    v_exp_f32 v17, v17 clamp
    v_exp_f32 v18, v18 clamp
    v_exp_f32 v19, v19 clamp
    v_exp_f32 v20, v20 clamp
    v_exp_f32 v21, v21 clamp
    v_exp_f32 v22, v22 clamp
    v_exp_f32 v23, v23 clamp
    v_max_f32 v24, 0, v72
    v_max_f32 v25, 0, v73
    v_max_f32 v26, 0, v74
    v_max_f32 v27, 0, v75
    v_max_f32 v28, 0, v88
    v_max_f32 v29, 0, v89
    v_max_f32 v30, 0, v90
    v_max_f32 v31, 0, v91
    v_pk_add_f32 v[16:17], v[16:17], v[24:25]
    v_pk_add_f32 v[18:19], v[18:19], v[26:27]
    v_pk_add_f32 v[20:21], v[20:21], v[28:29]
    v_pk_add_f32 v[22:23], v[22:23], v[30:31]
    v_pk_add_f32 v[16:17], v[16:17], s[66:67]
    v_pk_add_f32 v[18:19], v[18:19], s[66:67]
    v_pk_add_f32 v[20:21], v[20:21], s[66:67]
    v_pk_add_f32 v[22:23], v[22:23], s[66:67]
    v_cvt_pk_bf16_f32 v32, v16, v17
    v_cvt_pk_bf16_f32 v33, v18, v19
    v_cvt_pk_bf16_f32 v34, v20, v21
    v_cvt_pk_bf16_f32 v35, v22, v23
    s_add_u32 s69, s68, 151552
    buffer_store_dwordx4 v[32:35], v8, s[36:39], s69 offen sc0 sc1
    v_pk_mul_f32 v[36:37], v[104:105], s[64:65]
    v_pk_mul_f32 v[38:39], v[106:107], s[64:65]
    v_pk_mul_f32 v[40:41], v[120:121], s[64:65]
    v_pk_mul_f32 v[42:43], v[122:123], s[64:65]
    v_exp_f32 v36, v36 clamp
    v_exp_f32 v37, v37 clamp
    v_exp_f32 v38, v38 clamp
    v_exp_f32 v39, v39 clamp
    v_exp_f32 v40, v40 clamp
    v_exp_f32 v41, v41 clamp
    v_exp_f32 v42, v42 clamp
    v_exp_f32 v43, v43 clamp
    v_max_f32 v44, 0, v104
    v_max_f32 v45, 0, v105
    v_max_f32 v46, 0, v106
    v_max_f32 v47, 0, v107
    v_max_f32 v48, 0, v120
    v_max_f32 v49, 0, v121
    v_max_f32 v50, 0, v122
    v_max_f32 v51, 0, v123
    v_pk_add_f32 v[36:37], v[36:37], v[44:45]
    v_pk_add_f32 v[38:39], v[38:39], v[46:47]
    v_pk_add_f32 v[40:41], v[40:41], v[48:49]
    v_pk_add_f32 v[42:43], v[42:43], v[50:51]
    v_pk_add_f32 v[36:37], v[36:37], s[66:67]
    v_pk_add_f32 v[38:39], v[38:39], s[66:67]
    v_pk_add_f32 v[40:41], v[40:41], s[66:67]
    v_pk_add_f32 v[42:43], v[42:43], s[66:67]
    v_cvt_pk_bf16_f32 v52, v36, v37
    v_cvt_pk_bf16_f32 v53, v38, v39
    v_cvt_pk_bf16_f32 v54, v40, v41
    v_cvt_pk_bf16_f32 v55, v42, v43
    s_add_u32 s69, s68, 152576
    buffer_store_dwordx4 v[52:55], v8, s[36:39], s69 offen sc0 sc1
    v_pk_mul_f32 v[16:17], v[136:137], s[64:65]
    v_pk_mul_f32 v[18:19], v[138:139], s[64:65]
    v_pk_mul_f32 v[20:21], v[152:153], s[64:65]
    v_pk_mul_f32 v[22:23], v[154:155], s[64:65]
    v_exp_f32 v16, v16 clamp
    v_exp_f32 v17, v17 clamp
    v_exp_f32 v18, v18 clamp
    v_exp_f32 v19, v19 clamp
    v_exp_f32 v20, v20 clamp
    v_exp_f32 v21, v21 clamp
    v_exp_f32 v22, v22 clamp
    v_exp_f32 v23, v23 clamp
    v_max_f32 v24, 0, v136
    v_max_f32 v25, 0, v137
    v_max_f32 v26, 0, v138
    v_max_f32 v27, 0, v139
    v_max_f32 v28, 0, v152
    v_max_f32 v29, 0, v153
    v_max_f32 v30, 0, v154
    v_max_f32 v31, 0, v155
    v_pk_add_f32 v[16:17], v[16:17], v[24:25]
    v_pk_add_f32 v[18:19], v[18:19], v[26:27]
    v_pk_add_f32 v[20:21], v[20:21], v[28:29]
    v_pk_add_f32 v[22:23], v[22:23], v[30:31]
    v_pk_add_f32 v[16:17], v[16:17], s[66:67]
    v_pk_add_f32 v[18:19], v[18:19], s[66:67]
    v_pk_add_f32 v[20:21], v[20:21], s[66:67]
    v_pk_add_f32 v[22:23], v[22:23], s[66:67]
    v_cvt_pk_bf16_f32 v32, v16, v17
    v_cvt_pk_bf16_f32 v33, v18, v19
    v_cvt_pk_bf16_f32 v34, v20, v21
    v_cvt_pk_bf16_f32 v35, v22, v23
    s_add_u32 s69, s68, 153600
    buffer_store_dwordx4 v[32:35], v8, s[36:39], s69 offen sc0 sc1
    v_pk_mul_f32 v[36:37], v[168:169], s[64:65]
    v_pk_mul_f32 v[38:39], v[170:171], s[64:65]
    v_pk_mul_f32 v[40:41], v[184:185], s[64:65]
    v_pk_mul_f32 v[42:43], v[186:187], s[64:65]
    v_exp_f32 v36, v36 clamp
    v_exp_f32 v37, v37 clamp
    v_exp_f32 v38, v38 clamp
    v_exp_f32 v39, v39 clamp
    v_exp_f32 v40, v40 clamp
    v_exp_f32 v41, v41 clamp
    v_exp_f32 v42, v42 clamp
    v_exp_f32 v43, v43 clamp
    v_max_f32 v44, 0, v168
    v_max_f32 v45, 0, v169
    v_max_f32 v46, 0, v170
    v_max_f32 v47, 0, v171
    v_max_f32 v48, 0, v184
    v_max_f32 v49, 0, v185
    v_max_f32 v50, 0, v186
    v_max_f32 v51, 0, v187
    v_pk_add_f32 v[36:37], v[36:37], v[44:45]
    v_pk_add_f32 v[38:39], v[38:39], v[46:47]
    v_pk_add_f32 v[40:41], v[40:41], v[48:49]
    v_pk_add_f32 v[42:43], v[42:43], v[50:51]
    v_pk_add_f32 v[36:37], v[36:37], s[66:67]
    v_pk_add_f32 v[38:39], v[38:39], s[66:67]
    v_pk_add_f32 v[40:41], v[40:41], s[66:67]
    v_pk_add_f32 v[42:43], v[42:43], s[66:67]
    v_cvt_pk_bf16_f32 v52, v36, v37
    v_cvt_pk_bf16_f32 v53, v38, v39
    v_cvt_pk_bf16_f32 v54, v40, v41
    v_cvt_pk_bf16_f32 v55, v42, v43
    s_add_u32 s69, s68, 154624
    buffer_store_dwordx4 v[52:55], v8, s[36:39], s69 offen sc0 sc1
    v_pk_mul_f32 v[16:17], v[200:201], s[64:65]
    v_pk_mul_f32 v[18:19], v[202:203], s[64:65]
    v_pk_mul_f32 v[20:21], v[216:217], s[64:65]
    v_pk_mul_f32 v[22:23], v[218:219], s[64:65]
    v_exp_f32 v16, v16 clamp
    v_exp_f32 v17, v17 clamp
    v_exp_f32 v18, v18 clamp
    v_exp_f32 v19, v19 clamp
    v_exp_f32 v20, v20 clamp
    v_exp_f32 v21, v21 clamp
    v_exp_f32 v22, v22 clamp
    v_exp_f32 v23, v23 clamp
    v_max_f32 v24, 0, v200
    v_max_f32 v25, 0, v201
    v_max_f32 v26, 0, v202
    v_max_f32 v27, 0, v203
    v_max_f32 v28, 0, v216
    v_max_f32 v29, 0, v217
    v_max_f32 v30, 0, v218
    v_max_f32 v31, 0, v219
    v_pk_add_f32 v[16:17], v[16:17], v[24:25]
    v_pk_add_f32 v[18:19], v[18:19], v[26:27]
    v_pk_add_f32 v[20:21], v[20:21], v[28:29]
    v_pk_add_f32 v[22:23], v[22:23], v[30:31]
    v_pk_add_f32 v[16:17], v[16:17], s[66:67]
    v_pk_add_f32 v[18:19], v[18:19], s[66:67]
    v_pk_add_f32 v[20:21], v[20:21], s[66:67]
    v_pk_add_f32 v[22:23], v[22:23], s[66:67]
    v_cvt_pk_bf16_f32 v32, v16, v17
    v_cvt_pk_bf16_f32 v33, v18, v19
    v_cvt_pk_bf16_f32 v34, v20, v21
    v_cvt_pk_bf16_f32 v35, v22, v23
    s_add_u32 s69, s68, 155648
    buffer_store_dwordx4 v[32:35], v8, s[36:39], s69 offen sc0 sc1
    v_pk_mul_f32 v[36:37], v[76:77], s[64:65]
    v_pk_mul_f32 v[38:39], v[78:79], s[64:65]
    v_pk_mul_f32 v[40:41], v[92:93], s[64:65]
    v_pk_mul_f32 v[42:43], v[94:95], s[64:65]
    v_exp_f32 v36, v36 clamp
    v_exp_f32 v37, v37 clamp
    v_exp_f32 v38, v38 clamp
    v_exp_f32 v39, v39 clamp
    v_exp_f32 v40, v40 clamp
    v_exp_f32 v41, v41 clamp
    v_exp_f32 v42, v42 clamp
    v_exp_f32 v43, v43 clamp
    v_max_f32 v44, 0, v76
    v_max_f32 v45, 0, v77
    v_max_f32 v46, 0, v78
    v_max_f32 v47, 0, v79
    v_max_f32 v48, 0, v92
    v_max_f32 v49, 0, v93
    v_max_f32 v50, 0, v94
    v_max_f32 v51, 0, v95
    v_pk_add_f32 v[36:37], v[36:37], v[44:45]
    v_pk_add_f32 v[38:39], v[38:39], v[46:47]
    v_pk_add_f32 v[40:41], v[40:41], v[48:49]
    v_pk_add_f32 v[42:43], v[42:43], v[50:51]
    v_pk_add_f32 v[36:37], v[36:37], s[66:67]
    v_pk_add_f32 v[38:39], v[38:39], s[66:67]
    v_pk_add_f32 v[40:41], v[40:41], s[66:67]
    v_pk_add_f32 v[42:43], v[42:43], s[66:67]
    v_cvt_pk_bf16_f32 v52, v36, v37
    v_cvt_pk_bf16_f32 v53, v38, v39
    v_cvt_pk_bf16_f32 v54, v40, v41
    v_cvt_pk_bf16_f32 v55, v42, v43
    s_add_u32 s69, s68, 227328
    buffer_store_dwordx4 v[52:55], v8, s[36:39], s69 offen sc0 sc1
    v_pk_mul_f32 v[16:17], v[108:109], s[64:65]
    v_pk_mul_f32 v[18:19], v[110:111], s[64:65]
    v_pk_mul_f32 v[20:21], v[124:125], s[64:65]
    v_pk_mul_f32 v[22:23], v[126:127], s[64:65]
    v_exp_f32 v16, v16 clamp
    v_exp_f32 v17, v17 clamp
    v_exp_f32 v18, v18 clamp
    v_exp_f32 v19, v19 clamp
    v_exp_f32 v20, v20 clamp
    v_exp_f32 v21, v21 clamp
    v_exp_f32 v22, v22 clamp
    v_exp_f32 v23, v23 clamp
    v_max_f32 v24, 0, v108
    v_max_f32 v25, 0, v109
    v_max_f32 v26, 0, v110
    v_max_f32 v27, 0, v111
    v_max_f32 v28, 0, v124
    v_max_f32 v29, 0, v125
    v_max_f32 v30, 0, v126
    v_max_f32 v31, 0, v127
    v_pk_add_f32 v[16:17], v[16:17], v[24:25]
    v_pk_add_f32 v[18:19], v[18:19], v[26:27]
    v_pk_add_f32 v[20:21], v[20:21], v[28:29]
    v_pk_add_f32 v[22:23], v[22:23], v[30:31]
    v_pk_add_f32 v[16:17], v[16:17], s[66:67]
    v_pk_add_f32 v[18:19], v[18:19], s[66:67]
    v_pk_add_f32 v[20:21], v[20:21], s[66:67]
    v_pk_add_f32 v[22:23], v[22:23], s[66:67]
    v_cvt_pk_bf16_f32 v32, v16, v17
    v_cvt_pk_bf16_f32 v33, v18, v19
    v_cvt_pk_bf16_f32 v34, v20, v21
    v_cvt_pk_bf16_f32 v35, v22, v23
    s_add_u32 s69, s68, 228352
    buffer_store_dwordx4 v[32:35], v8, s[36:39], s69 offen sc0 sc1
    v_pk_mul_f32 v[36:37], v[140:141], s[64:65]
    v_pk_mul_f32 v[38:39], v[142:143], s[64:65]
    v_pk_mul_f32 v[40:41], v[156:157], s[64:65]
    v_pk_mul_f32 v[42:43], v[158:159], s[64:65]
    v_exp_f32 v36, v36 clamp
    v_exp_f32 v37, v37 clamp
    v_exp_f32 v38, v38 clamp
    v_exp_f32 v39, v39 clamp
    v_exp_f32 v40, v40 clamp
    v_exp_f32 v41, v41 clamp
    v_exp_f32 v42, v42 clamp
    v_exp_f32 v43, v43 clamp
    v_max_f32 v44, 0, v140
    v_max_f32 v45, 0, v141
    v_max_f32 v46, 0, v142
    v_max_f32 v47, 0, v143
    v_max_f32 v48, 0, v156
    v_max_f32 v49, 0, v157
    v_max_f32 v50, 0, v158
    v_max_f32 v51, 0, v159
    v_pk_add_f32 v[36:37], v[36:37], v[44:45]
    v_pk_add_f32 v[38:39], v[38:39], v[46:47]
    v_pk_add_f32 v[40:41], v[40:41], v[48:49]
    v_pk_add_f32 v[42:43], v[42:43], v[50:51]
    v_pk_add_f32 v[36:37], v[36:37], s[66:67]
    v_pk_add_f32 v[38:39], v[38:39], s[66:67]
    v_pk_add_f32 v[40:41], v[40:41], s[66:67]
    v_pk_add_f32 v[42:43], v[42:43], s[66:67]
    v_cvt_pk_bf16_f32 v52, v36, v37
    v_cvt_pk_bf16_f32 v53, v38, v39
    v_cvt_pk_bf16_f32 v54, v40, v41
    v_cvt_pk_bf16_f32 v55, v42, v43
    s_add_u32 s69, s68, 229376
    buffer_store_dwordx4 v[52:55], v8, s[36:39], s69 offen sc0 sc1
    v_pk_mul_f32 v[16:17], v[172:173], s[64:65]
    v_pk_mul_f32 v[18:19], v[174:175], s[64:65]
    v_pk_mul_f32 v[20:21], v[188:189], s[64:65]
    v_pk_mul_f32 v[22:23], v[190:191], s[64:65]
    v_exp_f32 v16, v16 clamp
    v_exp_f32 v17, v17 clamp
    v_exp_f32 v18, v18 clamp
    v_exp_f32 v19, v19 clamp
    v_exp_f32 v20, v20 clamp
    v_exp_f32 v21, v21 clamp
    v_exp_f32 v22, v22 clamp
    v_exp_f32 v23, v23 clamp
    v_max_f32 v24, 0, v172
    v_max_f32 v25, 0, v173
    v_max_f32 v26, 0, v174
    v_max_f32 v27, 0, v175
    v_max_f32 v28, 0, v188
    v_max_f32 v29, 0, v189
    v_max_f32 v30, 0, v190
    v_max_f32 v31, 0, v191
    v_pk_add_f32 v[16:17], v[16:17], v[24:25]
    v_pk_add_f32 v[18:19], v[18:19], v[26:27]
    v_pk_add_f32 v[20:21], v[20:21], v[28:29]
    v_pk_add_f32 v[22:23], v[22:23], v[30:31]
    v_pk_add_f32 v[16:17], v[16:17], s[66:67]
    v_pk_add_f32 v[18:19], v[18:19], s[66:67]
    v_pk_add_f32 v[20:21], v[20:21], s[66:67]
    v_pk_add_f32 v[22:23], v[22:23], s[66:67]
    v_cvt_pk_bf16_f32 v32, v16, v17
    v_cvt_pk_bf16_f32 v33, v18, v19
    v_cvt_pk_bf16_f32 v34, v20, v21
    v_cvt_pk_bf16_f32 v35, v22, v23
    s_add_u32 s69, s68, 230400
    buffer_store_dwordx4 v[32:35], v8, s[36:39], s69 offen sc0 sc1
    v_pk_mul_f32 v[36:37], v[204:205], s[64:65]
    v_pk_mul_f32 v[38:39], v[206:207], s[64:65]
    v_pk_mul_f32 v[40:41], v[220:221], s[64:65]
    v_pk_mul_f32 v[42:43], v[222:223], s[64:65]
    v_exp_f32 v36, v36 clamp
    v_exp_f32 v37, v37 clamp
    v_exp_f32 v38, v38 clamp
    v_exp_f32 v39, v39 clamp
    v_exp_f32 v40, v40 clamp
    v_exp_f32 v41, v41 clamp
    v_exp_f32 v42, v42 clamp
    v_exp_f32 v43, v43 clamp
    v_max_f32 v44, 0, v204
    v_max_f32 v45, 0, v205
    v_max_f32 v46, 0, v206
    v_max_f32 v47, 0, v207
    v_max_f32 v48, 0, v220
    v_max_f32 v49, 0, v221
    v_max_f32 v50, 0, v222
    v_max_f32 v51, 0, v223
    v_pk_add_f32 v[36:37], v[36:37], v[44:45]
    v_pk_add_f32 v[38:39], v[38:39], v[46:47]
    v_pk_add_f32 v[40:41], v[40:41], v[48:49]
    v_pk_add_f32 v[42:43], v[42:43], v[50:51]
    v_pk_add_f32 v[36:37], v[36:37], s[66:67]
    v_pk_add_f32 v[38:39], v[38:39], s[66:67]
    v_pk_add_f32 v[40:41], v[40:41], s[66:67]
    v_pk_add_f32 v[42:43], v[42:43], s[66:67]
    v_cvt_pk_bf16_f32 v52, v36, v37
    v_cvt_pk_bf16_f32 v53, v38, v39
    v_cvt_pk_bf16_f32 v54, v40, v41
    v_cvt_pk_bf16_f32 v55, v42, v43
    s_add_u32 s69, s68, 231424
    buffer_store_dwordx4 v[52:55], v8, s[36:39], s69 offen sc0 sc1
    s_cmp_eq_u32 s43, 13
    s_cbranch_scc0 K1_Q_END
    s_cmp_eq_u32 s45, 0
    s_cbranch_scc0 K1_Q_END
    v_cmp_gt_u32 vcc, 16, v1
    s_and_saveexec_b64 s[76:77], vcc
    v_lshlrev_b32 v9, 2, v1
    s_mov_b32 s64, 0xbfb8aa3b
    s_add_u32 s74, s74, 0xe40000
    v_mul_f32 v16, s64, v224
    v_mul_f32 v17, s64, v228
    v_mul_f32 v18, s64, v232
    v_mul_f32 v19, s64, v236
    v_exp_f32 v16, v16
    v_exp_f32 v17, v17
    v_exp_f32 v18, v18
    v_exp_f32 v19, v19
    s_nop 0
    v_add_f32 v16, 1.0, v16
    v_add_f32 v17, 1.0, v17
    v_add_f32 v18, 1.0, v18
    v_add_f32 v19, 1.0, v19
    v_rcp_f32 v16, v16
    v_rcp_f32 v17, v17
    v_rcp_f32 v18, v18
    v_rcp_f32 v19, v19
    s_nop 0
    buffer_store_dword v16, v9, s[36:39], s74 offen offset:0 sc0 sc1
    buffer_store_dword v17, v9, s[36:39], s74 offen offset:64 sc0 sc1
    buffer_store_dword v18, v9, s[36:39], s74 offen offset:128 sc0 sc1
    buffer_store_dword v19, v9, s[36:39], s74 offen offset:192 sc0 sc1
K1_Q_END:
    s_mov_b64 exec, -1
    s_endpgm
K1_KV:
    s_barrier
    ds_read_b128 v[16:19], v2 offset:0
    ds_read_b128 v[20:23], v2 offset:2048
    ds_read_b128 v[24:27], v2 offset:4096
    ds_read_b128 v[28:31], v2 offset:6144
    ds_read_b64_tr_b16 v[48:49], v4 offset:0
    ds_read_b64_tr_b16 v[50:51], v4 offset:1536
    ds_read_b64_tr_b16 v[52:53], v4 offset:12288
    ds_read_b64_tr_b16 v[54:55], v4 offset:13824
    ds_read_b64_tr_b16 v[56:57], v5 offset:0
    ds_read_b64_tr_b16 v[58:59], v5 offset:1536
K1_LOOP_kv:
    buffer_load_dword v13, v12, s[32:35], s78 offen
    s_add_u32 s78, s78, s79
    s_waitcnt lgkmcnt(4)
    v_mfma_f32_16x16x32_bf16 v[64:67], v[16:19], v[48:51], v[64:67]
    ds_read_b64_tr_b16 v[60:61], v5 offset:12288
    v_mfma_f32_16x16x32_bf16 v[68:71], v[20:23], v[48:51], v[68:71]
    ds_read_b64_tr_b16 v[62:63], v5 offset:13824
    v_mfma_f32_16x16x32_bf16 v[72:75], v[24:27], v[48:51], v[72:75]
    v_mfma_f32_16x16x32_bf16 v[76:79], v[28:31], v[48:51], v[76:79]
    s_waitcnt lgkmcnt(4)
    v_mfma_f32_16x16x32_bf16 v[80:83], v[16:19], v[52:55], v[80:83]
    ds_read_b64_tr_b16 v[48:49], v6 offset:0
    v_mfma_f32_16x16x32_bf16 v[84:87], v[20:23], v[52:55], v[84:87]
    ds_read_b64_tr_b16 v[50:51], v6 offset:1536
    v_mfma_f32_16x16x32_bf16 v[88:91], v[24:27], v[52:55], v[88:91]
    v_mfma_f32_16x16x32_bf16 v[92:95], v[28:31], v[52:55], v[92:95]
    s_waitcnt lgkmcnt(4)
    v_mfma_f32_16x16x32_bf16 v[96:99], v[16:19], v[56:59], v[96:99]
    ds_read_b64_tr_b16 v[52:53], v6 offset:12288
    v_mfma_f32_16x16x32_bf16 v[100:103], v[20:23], v[56:59], v[100:103]
    ds_read_b64_tr_b16 v[54:55], v6 offset:13824
    v_mfma_f32_16x16x32_bf16 v[104:107], v[24:27], v[56:59], v[104:107]
    v_mfma_f32_16x16x32_bf16 v[108:111], v[28:31], v[56:59], v[108:111]
    s_waitcnt lgkmcnt(4)
    v_mfma_f32_16x16x32_bf16 v[112:115], v[16:19], v[60:63], v[112:115]
    ds_read_b64_tr_b16 v[56:57], v7 offset:0
    v_mfma_f32_16x16x32_bf16 v[116:119], v[20:23], v[60:63], v[116:119]
    ds_read_b64_tr_b16 v[58:59], v7 offset:1536
    v_mfma_f32_16x16x32_bf16 v[120:123], v[24:27], v[60:63], v[120:123]
    v_mfma_f32_16x16x32_bf16 v[124:127], v[28:31], v[60:63], v[124:127]
    s_waitcnt lgkmcnt(4)
    v_mfma_f32_16x16x32_bf16 v[128:131], v[16:19], v[48:51], v[128:131]
    ds_read_b64_tr_b16 v[60:61], v7 offset:12288
    v_mfma_f32_16x16x32_bf16 v[132:135], v[20:23], v[48:51], v[132:135]
    ds_read_b64_tr_b16 v[62:63], v7 offset:13824
    v_mfma_f32_16x16x32_bf16 v[136:139], v[24:27], v[48:51], v[136:139]
    v_mfma_f32_16x16x32_bf16 v[140:143], v[28:31], v[48:51], v[140:143]
    s_waitcnt lgkmcnt(4)
    v_mfma_f32_16x16x32_bf16 v[144:147], v[16:19], v[52:55], v[144:147]
    ds_read_b64_tr_b16 v[48:49], v4 offset:128
    v_mfma_f32_16x16x32_bf16 v[148:151], v[20:23], v[52:55], v[148:151]
    ds_read_b64_tr_b16 v[50:51], v4 offset:1664
    v_mfma_f32_16x16x32_bf16 v[152:155], v[24:27], v[52:55], v[152:155]
    v_mfma_f32_16x16x32_bf16 v[156:159], v[28:31], v[52:55], v[156:159]
    s_waitcnt lgkmcnt(4)
    v_mfma_f32_16x16x32_bf16 v[160:163], v[16:19], v[56:59], v[160:163]
    ds_read_b64_tr_b16 v[52:53], v4 offset:12416
    v_mfma_f32_16x16x32_bf16 v[164:167], v[20:23], v[56:59], v[164:167]
    ds_read_b64_tr_b16 v[54:55], v4 offset:13952
    v_mfma_f32_16x16x32_bf16 v[168:171], v[24:27], v[56:59], v[168:171]
    v_mfma_f32_16x16x32_bf16 v[172:175], v[28:31], v[56:59], v[172:175]
    s_waitcnt lgkmcnt(4)
    v_mfma_f32_16x16x32_bf16 v[176:179], v[16:19], v[60:63], v[176:179]
    v_mfma_f32_16x16x32_bf16 v[180:183], v[20:23], v[60:63], v[180:183]
    v_mfma_f32_16x16x32_bf16 v[184:187], v[24:27], v[60:63], v[184:187]
    v_mfma_f32_16x16x32_bf16 v[188:191], v[28:31], v[60:63], v[188:191]
    s_waitcnt lgkmcnt(0)
    s_barrier
    v_mfma_f32_16x16x32_bf16 v[192:195], v[16:19], v[48:51], v[192:195]
    ds_read_b128 v[32:35], v3 offset:0
    ds_read_b128 v[36:39], v3 offset:2048
    v_mfma_f32_16x16x32_bf16 v[196:199], v[20:23], v[48:51], v[196:199]
    ds_read_b128 v[40:43], v3 offset:4096
    ds_read_b128 v[44:47], v3 offset:6144
    v_mfma_f32_16x16x32_bf16 v[200:203], v[24:27], v[48:51], v[200:203]
    ds_read_b64_tr_b16 v[56:57], v4 offset:24576
    ds_read_b64_tr_b16 v[58:59], v4 offset:26112
    v_mfma_f32_16x16x32_bf16 v[204:207], v[28:31], v[48:51], v[204:207]
    ds_read_b64_tr_b16 v[60:61], v4 offset:36864
    ds_read_b64_tr_b16 v[62:63], v4 offset:38400
    v_mfma_f32_16x16x32_bf16 v[208:211], v[16:19], v[52:55], v[208:211]
    ds_read_b64_tr_b16 v[48:49], v5 offset:24576
    v_mfma_f32_16x16x32_bf16 v[212:215], v[20:23], v[52:55], v[212:215]
    ds_read_b64_tr_b16 v[50:51], v5 offset:26112
    v_mfma_f32_16x16x32_bf16 v[216:219], v[24:27], v[52:55], v[216:219]
    v_mfma_f32_16x16x32_bf16 v[220:223], v[28:31], v[52:55], v[220:223]
    s_waitcnt lgkmcnt(4)
    v_mfma_f32_16x16x32_bf16 v[64:67], v[32:35], v[56:59], v[64:67]
    ds_read_b64_tr_b16 v[52:53], v5 offset:36864
    v_mfma_f32_16x16x32_bf16 v[68:71], v[36:39], v[56:59], v[68:71]
    ds_read_b64_tr_b16 v[54:55], v5 offset:38400
    v_mfma_f32_16x16x32_bf16 v[72:75], v[40:43], v[56:59], v[72:75]
    v_mfma_f32_16x16x32_bf16 v[76:79], v[44:47], v[56:59], v[76:79]
    s_waitcnt lgkmcnt(4)
    v_mfma_f32_16x16x32_bf16 v[80:83], v[32:35], v[60:63], v[80:83]
    ds_read_b64_tr_b16 v[56:57], v6 offset:24576
    v_mfma_f32_16x16x32_bf16 v[84:87], v[36:39], v[60:63], v[84:87]
    ds_read_b64_tr_b16 v[58:59], v6 offset:26112
    v_mfma_f32_16x16x32_bf16 v[88:91], v[40:43], v[60:63], v[88:91]
    v_mfma_f32_16x16x32_bf16 v[92:95], v[44:47], v[60:63], v[92:95]
    s_waitcnt lgkmcnt(4)
    v_mfma_f32_16x16x32_bf16 v[96:99], v[32:35], v[48:51], v[96:99]
    ds_read_b64_tr_b16 v[60:61], v6 offset:36864
    v_mfma_f32_16x16x32_bf16 v[100:103], v[36:39], v[48:51], v[100:103]
    ds_read_b64_tr_b16 v[62:63], v6 offset:38400
    v_mfma_f32_16x16x32_bf16 v[104:107], v[40:43], v[48:51], v[104:107]
    v_mfma_f32_16x16x32_bf16 v[108:111], v[44:47], v[48:51], v[108:111]
    s_waitcnt lgkmcnt(4)
    v_mfma_f32_16x16x32_bf16 v[112:115], v[32:35], v[52:55], v[112:115]
    ds_read_b64_tr_b16 v[48:49], v7 offset:24576
    v_mfma_f32_16x16x32_bf16 v[116:119], v[36:39], v[52:55], v[116:119]
    ds_read_b64_tr_b16 v[50:51], v7 offset:26112
    v_mfma_f32_16x16x32_bf16 v[120:123], v[40:43], v[52:55], v[120:123]
    v_mfma_f32_16x16x32_bf16 v[124:127], v[44:47], v[52:55], v[124:127]
    s_waitcnt lgkmcnt(4)
    v_mfma_f32_16x16x32_bf16 v[128:131], v[32:35], v[56:59], v[128:131]
    ds_read_b64_tr_b16 v[52:53], v7 offset:36864
    v_mfma_f32_16x16x32_bf16 v[132:135], v[36:39], v[56:59], v[132:135]
    ds_read_b64_tr_b16 v[54:55], v7 offset:38400
    v_mfma_f32_16x16x32_bf16 v[136:139], v[40:43], v[56:59], v[136:139]
    v_mfma_f32_16x16x32_bf16 v[140:143], v[44:47], v[56:59], v[140:143]
    s_waitcnt lgkmcnt(4)
    v_mfma_f32_16x16x32_bf16 v[144:147], v[32:35], v[60:63], v[144:147]
    ds_read_b64_tr_b16 v[56:57], v4 offset:24704
    v_mfma_f32_16x16x32_bf16 v[148:151], v[36:39], v[60:63], v[148:151]
    ds_read_b64_tr_b16 v[58:59], v4 offset:26240
    v_mfma_f32_16x16x32_bf16 v[152:155], v[40:43], v[60:63], v[152:155]
    v_mfma_f32_16x16x32_bf16 v[156:159], v[44:47], v[60:63], v[156:159]
    s_waitcnt lgkmcnt(4)
    v_mfma_f32_16x16x32_bf16 v[160:163], v[32:35], v[48:51], v[160:163]
    ds_read_b64_tr_b16 v[60:61], v4 offset:36992
    v_mfma_f32_16x16x32_bf16 v[164:167], v[36:39], v[48:51], v[164:167]
    ds_read_b64_tr_b16 v[62:63], v4 offset:38528
    v_mfma_f32_16x16x32_bf16 v[168:171], v[40:43], v[48:51], v[168:171]
    v_mfma_f32_16x16x32_bf16 v[172:175], v[44:47], v[48:51], v[172:175]
    s_waitcnt lgkmcnt(4)
    v_mfma_f32_16x16x32_bf16 v[176:179], v[32:35], v[52:55], v[176:179]
    v_mfma_f32_16x16x32_bf16 v[180:183], v[36:39], v[52:55], v[180:183]
    v_mfma_f32_16x16x32_bf16 v[184:187], v[40:43], v[52:55], v[184:187]
    v_mfma_f32_16x16x32_bf16 v[188:191], v[44:47], v[52:55], v[188:191]
    s_waitcnt lgkmcnt(0)
    s_barrier
    v_add_u32 v4, s75, v4
    v_add_u32 v5, s75, v5
    v_add_u32 v6, s75, v6
    v_add_u32 v7, s75, v7
    s_sub_u32 s75, 0, s75
    s_add_u32 s70, s70, 16384
    s_cmp_eq_u32 s70, 49152
    s_cselect_b32 s73, s70, 0
    s_sub_u32 s70, s70, s73
    s_sub_u32 s73, 16384, s73
    v_add_u32 v2, s73, v2
    v_add_u32 v3, s73, v3
    v_mfma_f32_16x16x32_bf16 v[192:195], v[32:35], v[56:59], v[192:195]
    ds_read_b128 v[16:19], v2 offset:0
    ds_read_b128 v[20:23], v2 offset:2048
    v_mfma_f32_16x16x32_bf16 v[196:199], v[36:39], v[56:59], v[196:199]
    ds_read_b128 v[24:27], v2 offset:4096
    ds_read_b128 v[28:31], v2 offset:6144
    v_mfma_f32_16x16x32_bf16 v[200:203], v[40:43], v[56:59], v[200:203]
    ds_read_b64_tr_b16 v[48:49], v4 offset:0
    ds_read_b64_tr_b16 v[50:51], v4 offset:1536
    v_mfma_f32_16x16x32_bf16 v[204:207], v[44:47], v[56:59], v[204:207]
    ds_read_b64_tr_b16 v[52:53], v4 offset:12288
    ds_read_b64_tr_b16 v[54:55], v4 offset:13824
    v_mfma_f32_16x16x32_bf16 v[208:211], v[32:35], v[60:63], v[208:211]
    ds_read_b64_tr_b16 v[56:57], v5 offset:0
    v_mfma_f32_16x16x32_bf16 v[212:215], v[36:39], v[60:63], v[212:215]
    ds_read_b64_tr_b16 v[58:59], v5 offset:1536
    v_mfma_f32_16x16x32_bf16 v[216:219], v[40:43], v[60:63], v[216:219]
    v_mfma_f32_16x16x32_bf16 v[220:223], v[44:47], v[60:63], v[220:223]
    s_sub_u32 s71, s71, 1
    s_cmp_lg_u32 s71, 0
    s_cbranch_scc1 K1_LOOP_kv
    s_waitcnt lgkmcnt(0) vmcnt(0)
    s_nop 7
    v_mov_b32 v9, 0
    buffer_load_dword v10, v9, s[52:55], 0 offen sc0 sc1
    s_mov_b32 s64, 0x3fb8aa3b
    s_mov_b32 s65, 0x3fb8aa3b
    s_mov_b32 s66, 0x358637bd
    s_mov_b32 s67, 0x358637bd
    v_mov_b32 v48, 0x3f803f80
    v_mov_b32 v49, 0x3f803f80
    v_mov_b32 v50, 0x3f803f80
    v_mov_b32 v51, 0x3f803f80
    v_pk_mul_f32 v[16:17], v[64:65], s[64:65]
    v_pk_mul_f32 v[18:19], v[66:67], s[64:65]
    v_pk_mul_f32 v[20:21], v[68:69], s[64:65]
    v_pk_mul_f32 v[22:23], v[70:71], s[64:65]
    v_exp_f32 v16, v16 clamp
    v_exp_f32 v17, v17 clamp
    v_exp_f32 v18, v18 clamp
    v_exp_f32 v19, v19 clamp
    v_exp_f32 v20, v20 clamp
    v_exp_f32 v21, v21 clamp
    v_exp_f32 v22, v22 clamp
    v_exp_f32 v23, v23 clamp
    v_max_f32 v24, 0, v64
    v_max_f32 v25, 0, v65
    v_max_f32 v26, 0, v66
    v_max_f32 v27, 0, v67
    v_max_f32 v28, 0, v68
    v_max_f32 v29, 0, v69
    v_max_f32 v30, 0, v70
    v_max_f32 v31, 0, v71
    v_pk_add_f32 v[16:17], v[16:17], v[24:25]
    v_pk_add_f32 v[18:19], v[18:19], v[26:27]
    v_pk_add_f32 v[20:21], v[20:21], v[28:29]
    v_pk_add_f32 v[22:23], v[22:23], v[30:31]
    v_pk_add_f32 v[16:17], v[16:17], s[66:67]
    v_pk_add_f32 v[18:19], v[18:19], s[66:67]
    v_pk_add_f32 v[20:21], v[20:21], s[66:67]
    v_pk_add_f32 v[22:23], v[22:23], s[66:67]
    v_cvt_pk_bf16_f32 v64, v16, v17
    v_cvt_pk_bf16_f32 v65, v18, v19
    v_cvt_pk_bf16_f32 v66, v20, v21
    v_cvt_pk_bf16_f32 v67, v22, v23
    v_cvt_pk_bf16_f32 v80, v80, v81
    v_cvt_pk_bf16_f32 v81, v82, v83
    v_cvt_pk_bf16_f32 v82, v84, v85
    v_cvt_pk_bf16_f32 v83, v86, v87
    v_pk_mul_f32 v[32:33], v[96:97], s[64:65]
    v_pk_mul_f32 v[34:35], v[98:99], s[64:65]
    v_pk_mul_f32 v[36:37], v[100:101], s[64:65]
    v_pk_mul_f32 v[38:39], v[102:103], s[64:65]
    v_exp_f32 v32, v32 clamp
    v_exp_f32 v33, v33 clamp
    v_exp_f32 v34, v34 clamp
    v_exp_f32 v35, v35 clamp
    v_exp_f32 v36, v36 clamp
    v_exp_f32 v37, v37 clamp
    v_exp_f32 v38, v38 clamp
    v_exp_f32 v39, v39 clamp
    v_max_f32 v40, 0, v96
    v_max_f32 v41, 0, v97
    v_max_f32 v42, 0, v98
    v_max_f32 v43, 0, v99
    v_max_f32 v44, 0, v100
    v_max_f32 v45, 0, v101
    v_max_f32 v46, 0, v102
    v_max_f32 v47, 0, v103
    v_pk_add_f32 v[32:33], v[32:33], v[40:41]
    v_pk_add_f32 v[34:35], v[34:35], v[42:43]
    v_pk_add_f32 v[36:37], v[36:37], v[44:45]
    v_pk_add_f32 v[38:39], v[38:39], v[46:47]
    v_pk_add_f32 v[32:33], v[32:33], s[66:67]
    v_pk_add_f32 v[34:35], v[34:35], s[66:67]
    v_pk_add_f32 v[36:37], v[36:37], s[66:67]
    v_pk_add_f32 v[38:39], v[38:39], s[66:67]
    v_cvt_pk_bf16_f32 v96, v32, v33
    v_cvt_pk_bf16_f32 v97, v34, v35
    v_cvt_pk_bf16_f32 v98, v36, v37
    v_cvt_pk_bf16_f32 v99, v38, v39
    v_cvt_pk_bf16_f32 v112, v112, v113
    v_cvt_pk_bf16_f32 v113, v114, v115
    v_cvt_pk_bf16_f32 v114, v116, v117
    v_cvt_pk_bf16_f32 v115, v118, v119
    v_pk_mul_f32 v[16:17], v[128:129], s[64:65]
    v_pk_mul_f32 v[18:19], v[130:131], s[64:65]
    v_pk_mul_f32 v[20:21], v[132:133], s[64:65]
    v_pk_mul_f32 v[22:23], v[134:135], s[64:65]
    v_exp_f32 v16, v16 clamp
    v_exp_f32 v17, v17 clamp
    v_exp_f32 v18, v18 clamp
    v_exp_f32 v19, v19 clamp
    v_exp_f32 v20, v20 clamp
    v_exp_f32 v21, v21 clamp
    v_exp_f32 v22, v22 clamp
    v_exp_f32 v23, v23 clamp
    v_max_f32 v24, 0, v128
    v_max_f32 v25, 0, v129
    v_max_f32 v26, 0, v130
    v_max_f32 v27, 0, v131
    v_max_f32 v28, 0, v132
    v_max_f32 v29, 0, v133
    v_max_f32 v30, 0, v134
    v_max_f32 v31, 0, v135
    v_pk_add_f32 v[16:17], v[16:17], v[24:25]
    v_pk_add_f32 v[18:19], v[18:19], v[26:27]
    v_pk_add_f32 v[20:21], v[20:21], v[28:29]
    v_pk_add_f32 v[22:23], v[22:23], v[30:31]
    v_pk_add_f32 v[16:17], v[16:17], s[66:67]
    v_pk_add_f32 v[18:19], v[18:19], s[66:67]
    v_pk_add_f32 v[20:21], v[20:21], s[66:67]
    v_pk_add_f32 v[22:23], v[22:23], s[66:67]
    v_cvt_pk_bf16_f32 v128, v16, v17
    v_cvt_pk_bf16_f32 v129, v18, v19
    v_cvt_pk_bf16_f32 v130, v20, v21
    v_cvt_pk_bf16_f32 v131, v22, v23
    v_cvt_pk_bf16_f32 v144, v144, v145
    v_cvt_pk_bf16_f32 v145, v146, v147
    v_cvt_pk_bf16_f32 v146, v148, v149
    v_cvt_pk_bf16_f32 v147, v150, v151
    v_pk_mul_f32 v[32:33], v[160:161], s[64:65]
    v_pk_mul_f32 v[34:35], v[162:163], s[64:65]
    v_pk_mul_f32 v[36:37], v[164:165], s[64:65]
    v_pk_mul_f32 v[38:39], v[166:167], s[64:65]
    v_exp_f32 v32, v32 clamp
    v_exp_f32 v33, v33 clamp
    v_exp_f32 v34, v34 clamp
    v_exp_f32 v35, v35 clamp
    v_exp_f32 v36, v36 clamp
    v_exp_f32 v37, v37 clamp
    v_exp_f32 v38, v38 clamp
    v_exp_f32 v39, v39 clamp
    v_max_f32 v40, 0, v160
    v_max_f32 v41, 0, v161
    v_max_f32 v42, 0, v162
    v_max_f32 v43, 0, v163
    v_max_f32 v44, 0, v164
    v_max_f32 v45, 0, v165
    v_max_f32 v46, 0, v166
    v_max_f32 v47, 0, v167
    v_pk_add_f32 v[32:33], v[32:33], v[40:41]
    v_pk_add_f32 v[34:35], v[34:35], v[42:43]
    v_pk_add_f32 v[36:37], v[36:37], v[44:45]
    v_pk_add_f32 v[38:39], v[38:39], v[46:47]
    v_pk_add_f32 v[32:33], v[32:33], s[66:67]
    v_pk_add_f32 v[34:35], v[34:35], s[66:67]
    v_pk_add_f32 v[36:37], v[36:37], s[66:67]
    v_pk_add_f32 v[38:39], v[38:39], s[66:67]
    v_cvt_pk_bf16_f32 v160, v32, v33
    v_cvt_pk_bf16_f32 v161, v34, v35
    v_cvt_pk_bf16_f32 v162, v36, v37
    v_cvt_pk_bf16_f32 v163, v38, v39
    v_cvt_pk_bf16_f32 v176, v176, v177
    v_cvt_pk_bf16_f32 v177, v178, v179
    v_cvt_pk_bf16_f32 v178, v180, v181
    v_cvt_pk_bf16_f32 v179, v182, v183
    v_pk_mul_f32 v[16:17], v[192:193], s[64:65]
    v_pk_mul_f32 v[18:19], v[194:195], s[64:65]
    v_pk_mul_f32 v[20:21], v[196:197], s[64:65]
    v_pk_mul_f32 v[22:23], v[198:199], s[64:65]
    v_exp_f32 v16, v16 clamp
    v_exp_f32 v17, v17 clamp
    v_exp_f32 v18, v18 clamp
    v_exp_f32 v19, v19 clamp
    v_exp_f32 v20, v20 clamp
    v_exp_f32 v21, v21 clamp
    v_exp_f32 v22, v22 clamp
    v_exp_f32 v23, v23 clamp
    v_max_f32 v24, 0, v192
    v_max_f32 v25, 0, v193
    v_max_f32 v26, 0, v194
    v_max_f32 v27, 0, v195
    v_max_f32 v28, 0, v196
    v_max_f32 v29, 0, v197
    v_max_f32 v30, 0, v198
    v_max_f32 v31, 0, v199
    v_pk_add_f32 v[16:17], v[16:17], v[24:25]
    v_pk_add_f32 v[18:19], v[18:19], v[26:27]
    v_pk_add_f32 v[20:21], v[20:21], v[28:29]
    v_pk_add_f32 v[22:23], v[22:23], v[30:31]
    v_pk_add_f32 v[16:17], v[16:17], s[66:67]
    v_pk_add_f32 v[18:19], v[18:19], s[66:67]
    v_pk_add_f32 v[20:21], v[20:21], s[66:67]
    v_pk_add_f32 v[22:23], v[22:23], s[66:67]
    v_cvt_pk_bf16_f32 v192, v16, v17
    v_cvt_pk_bf16_f32 v193, v18, v19
    v_cvt_pk_bf16_f32 v194, v20, v21
    v_cvt_pk_bf16_f32 v195, v22, v23
    v_cvt_pk_bf16_f32 v208, v208, v209
    v_cvt_pk_bf16_f32 v209, v210, v211
    v_cvt_pk_bf16_f32 v210, v212, v213
    v_cvt_pk_bf16_f32 v211, v214, v215
    s_nop 1
    v_mfma_f32_16x16x32_bf16 v[68:71], v[80:83], v[64:67], 0
    v_pk_mul_f32 v[16:17], v[72:73], s[64:65]
    v_pk_mul_f32 v[18:19], v[74:75], s[64:65]
    v_pk_mul_f32 v[20:21], v[76:77], s[64:65]
    v_pk_mul_f32 v[22:23], v[78:79], s[64:65]
    v_exp_f32 v16, v16 clamp
    v_exp_f32 v17, v17 clamp
    v_exp_f32 v18, v18 clamp
    v_exp_f32 v19, v19 clamp
    v_exp_f32 v20, v20 clamp
    v_exp_f32 v21, v21 clamp
    v_mfma_f32_16x16x32_bf16 v[84:87], v[112:115], v[64:67], 0
    v_exp_f32 v22, v22 clamp
    v_exp_f32 v23, v23 clamp
    v_max_f32 v24, 0, v72
    v_max_f32 v25, 0, v73
    v_max_f32 v26, 0, v74
    v_max_f32 v27, 0, v75
    v_max_f32 v28, 0, v76
    v_max_f32 v29, 0, v77
    v_max_f32 v30, 0, v78
    v_max_f32 v31, 0, v79
    v_mfma_f32_16x16x32_bf16 v[100:103], v[80:83], v[96:99], 0
    v_pk_add_f32 v[16:17], v[16:17], v[24:25]
    v_pk_add_f32 v[18:19], v[18:19], v[26:27]
    v_pk_add_f32 v[20:21], v[20:21], v[28:29]
    v_pk_add_f32 v[22:23], v[22:23], v[30:31]
    v_pk_add_f32 v[16:17], v[16:17], s[66:67]
    v_pk_add_f32 v[18:19], v[18:19], s[66:67]
    v_pk_add_f32 v[20:21], v[20:21], s[66:67]
    v_pk_add_f32 v[22:23], v[22:23], s[66:67]
    v_cvt_pk_bf16_f32 v72, v16, v17
    v_cvt_pk_bf16_f32 v73, v18, v19
    v_mfma_f32_16x16x32_bf16 v[116:119], v[112:115], v[96:99], 0
    v_cvt_pk_bf16_f32 v74, v20, v21
    v_cvt_pk_bf16_f32 v75, v22, v23
    v_cvt_pk_bf16_f32 v88, v88, v89
    v_cvt_pk_bf16_f32 v89, v90, v91
    v_cvt_pk_bf16_f32 v90, v92, v93
    v_cvt_pk_bf16_f32 v91, v94, v95
    v_pk_mul_f32 v[32:33], v[104:105], s[64:65]
    v_pk_mul_f32 v[34:35], v[106:107], s[64:65]
    v_pk_mul_f32 v[36:37], v[108:109], s[64:65]
    v_pk_mul_f32 v[38:39], v[110:111], s[64:65]
    v_mfma_f32_16x16x32_bf16 v[132:135], v[144:147], v[96:99], 0
    v_exp_f32 v32, v32 clamp
    v_exp_f32 v33, v33 clamp
    v_exp_f32 v34, v34 clamp
    v_exp_f32 v35, v35 clamp
    v_exp_f32 v36, v36 clamp
    v_exp_f32 v37, v37 clamp
    v_exp_f32 v38, v38 clamp
    v_exp_f32 v39, v39 clamp
    v_max_f32 v40, 0, v104
    v_max_f32 v41, 0, v105
    v_mfma_f32_16x16x32_bf16 v[148:151], v[112:115], v[128:131], 0
    v_max_f32 v42, 0, v106
    v_max_f32 v43, 0, v107
    v_max_f32 v44, 0, v108
    v_max_f32 v45, 0, v109
    v_max_f32 v46, 0, v110
    v_max_f32 v47, 0, v111
    v_pk_add_f32 v[32:33], v[32:33], v[40:41]
    v_pk_add_f32 v[34:35], v[34:35], v[42:43]
    v_pk_add_f32 v[36:37], v[36:37], v[44:45]
    v_pk_add_f32 v[38:39], v[38:39], v[46:47]
    v_mfma_f32_16x16x32_bf16 v[164:167], v[144:147], v[128:131], 0
    v_pk_add_f32 v[32:33], v[32:33], s[66:67]
    v_pk_add_f32 v[34:35], v[34:35], s[66:67]
    v_pk_add_f32 v[36:37], v[36:37], s[66:67]
    v_pk_add_f32 v[38:39], v[38:39], s[66:67]
    v_cvt_pk_bf16_f32 v104, v32, v33
    v_cvt_pk_bf16_f32 v105, v34, v35
    v_cvt_pk_bf16_f32 v106, v36, v37
    v_cvt_pk_bf16_f32 v107, v38, v39
    v_cvt_pk_bf16_f32 v120, v120, v121
    v_cvt_pk_bf16_f32 v121, v122, v123
    v_mfma_f32_16x16x32_bf16 v[180:183], v[176:179], v[128:131], 0
    v_cvt_pk_bf16_f32 v122, v124, v125
    v_cvt_pk_bf16_f32 v123, v126, v127
    v_pk_mul_f32 v[16:17], v[136:137], s[64:65]
    v_pk_mul_f32 v[18:19], v[138:139], s[64:65]
    v_pk_mul_f32 v[20:21], v[140:141], s[64:65]
    v_pk_mul_f32 v[22:23], v[142:143], s[64:65]
    v_exp_f32 v16, v16 clamp
    v_exp_f32 v17, v17 clamp
    v_exp_f32 v18, v18 clamp
    v_exp_f32 v19, v19 clamp
    v_mfma_f32_16x16x32_bf16 v[196:199], v[144:147], v[160:163], 0
    v_exp_f32 v20, v20 clamp
    v_exp_f32 v21, v21 clamp
    v_exp_f32 v22, v22 clamp
    v_exp_f32 v23, v23 clamp
    v_max_f32 v24, 0, v136
    v_max_f32 v25, 0, v137
    v_max_f32 v26, 0, v138
    v_max_f32 v27, 0, v139
    v_max_f32 v28, 0, v140
    v_max_f32 v29, 0, v141
    v_mfma_f32_16x16x32_bf16 v[212:215], v[176:179], v[160:163], 0
    v_max_f32 v30, 0, v142
    v_max_f32 v31, 0, v143
    v_pk_add_f32 v[16:17], v[16:17], v[24:25]
    v_pk_add_f32 v[18:19], v[18:19], v[26:27]
    v_pk_add_f32 v[20:21], v[20:21], v[28:29]
    v_pk_add_f32 v[22:23], v[22:23], v[30:31]
    v_pk_add_f32 v[16:17], v[16:17], s[66:67]
    v_pk_add_f32 v[18:19], v[18:19], s[66:67]
    v_pk_add_f32 v[20:21], v[20:21], s[66:67]
    v_pk_add_f32 v[22:23], v[22:23], s[66:67]
    v_mfma_f32_16x16x32_bf16 v[224:227], v[208:211], v[160:163], 0
    v_cvt_pk_bf16_f32 v136, v16, v17
    v_cvt_pk_bf16_f32 v137, v18, v19
    v_cvt_pk_bf16_f32 v138, v20, v21
    v_cvt_pk_bf16_f32 v139, v22, v23
    v_cvt_pk_bf16_f32 v152, v152, v153
    v_cvt_pk_bf16_f32 v153, v154, v155
    v_cvt_pk_bf16_f32 v154, v156, v157
    v_cvt_pk_bf16_f32 v155, v158, v159
    v_pk_mul_f32 v[32:33], v[168:169], s[64:65]
    v_pk_mul_f32 v[34:35], v[170:171], s[64:65]
    v_mfma_f32_16x16x32_bf16 v[228:231], v[176:179], v[192:195], 0
    v_pk_mul_f32 v[36:37], v[172:173], s[64:65]
    v_pk_mul_f32 v[38:39], v[174:175], s[64:65]
    v_exp_f32 v32, v32 clamp
    v_exp_f32 v33, v33 clamp
    v_exp_f32 v34, v34 clamp
    v_exp_f32 v35, v35 clamp
    v_exp_f32 v36, v36 clamp
    v_exp_f32 v37, v37 clamp
    v_exp_f32 v38, v38 clamp
    v_exp_f32 v39, v39 clamp
    v_mfma_f32_16x16x32_bf16 v[232:235], v[208:211], v[192:195], 0
    v_max_f32 v40, 0, v168
    v_max_f32 v41, 0, v169
    v_max_f32 v42, 0, v170
    v_max_f32 v43, 0, v171
    v_max_f32 v44, 0, v172
    v_max_f32 v45, 0, v173
    v_max_f32 v46, 0, v174
    v_max_f32 v47, 0, v175
    v_pk_add_f32 v[32:33], v[32:33], v[40:41]
    v_pk_add_f32 v[34:35], v[34:35], v[42:43]
    v_mfma_f32_16x16x32_bf16 v[236:239], v[48:51], v[64:67], 0
    v_pk_add_f32 v[36:37], v[36:37], v[44:45]
    v_pk_add_f32 v[38:39], v[38:39], v[46:47]
    v_pk_add_f32 v[32:33], v[32:33], s[66:67]
    v_pk_add_f32 v[34:35], v[34:35], s[66:67]
    v_pk_add_f32 v[36:37], v[36:37], s[66:67]
    v_pk_add_f32 v[38:39], v[38:39], s[66:67]
    v_cvt_pk_bf16_f32 v168, v32, v33
    v_cvt_pk_bf16_f32 v169, v34, v35
    v_cvt_pk_bf16_f32 v170, v36, v37
    v_cvt_pk_bf16_f32 v171, v38, v39
    v_mfma_f32_16x16x32_bf16 v[240:243], v[48:51], v[96:99], 0
    v_cvt_pk_bf16_f32 v184, v184, v185
    v_cvt_pk_bf16_f32 v185, v186, v187
    v_cvt_pk_bf16_f32 v186, v188, v189
    v_cvt_pk_bf16_f32 v187, v190, v191
    v_pk_mul_f32 v[16:17], v[200:201], s[64:65]
    v_pk_mul_f32 v[18:19], v[202:203], s[64:65]
    v_pk_mul_f32 v[20:21], v[204:205], s[64:65]
    v_pk_mul_f32 v[22:23], v[206:207], s[64:65]
    v_exp_f32 v16, v16 clamp
    v_exp_f32 v17, v17 clamp
    v_mfma_f32_16x16x32_bf16 v[244:247], v[48:51], v[128:131], 0
    v_exp_f32 v18, v18 clamp
    v_exp_f32 v19, v19 clamp
    v_exp_f32 v20, v20 clamp
    v_exp_f32 v21, v21 clamp
    v_exp_f32 v22, v22 clamp
    v_exp_f32 v23, v23 clamp
    v_max_f32 v24, 0, v200
    v_max_f32 v25, 0, v201
    v_max_f32 v26, 0, v202
    v_max_f32 v27, 0, v203
    v_mfma_f32_16x16x32_bf16 v[248:251], v[48:51], v[160:163], 0
    v_max_f32 v28, 0, v204
    v_max_f32 v29, 0, v205
    v_max_f32 v30, 0, v206
    v_max_f32 v31, 0, v207
    v_pk_add_f32 v[16:17], v[16:17], v[24:25]
    v_pk_add_f32 v[18:19], v[18:19], v[26:27]
    v_pk_add_f32 v[20:21], v[20:21], v[28:29]
    v_pk_add_f32 v[22:23], v[22:23], v[30:31]
    v_pk_add_f32 v[16:17], v[16:17], s[66:67]
    v_pk_add_f32 v[18:19], v[18:19], s[66:67]
    v_mfma_f32_16x16x32_bf16 v[252:255], v[48:51], v[192:195], 0
    v_pk_add_f32 v[20:21], v[20:21], s[66:67]
    v_pk_add_f32 v[22:23], v[22:23], s[66:67]
    v_cvt_pk_bf16_f32 v200, v16, v17
    v_cvt_pk_bf16_f32 v201, v18, v19
    v_cvt_pk_bf16_f32 v202, v20, v21
    v_cvt_pk_bf16_f32 v203, v22, v23
    v_cvt_pk_bf16_f32 v216, v216, v217
    v_cvt_pk_bf16_f32 v217, v218, v219
    v_cvt_pk_bf16_f32 v218, v220, v221
    v_cvt_pk_bf16_f32 v219, v222, v223
    s_barrier
    s_nop 0
    v_mfma_f32_16x16x32_bf16 v[68:71], v[88:91], v[72:75], v[68:71]
    v_mfma_f32_16x16x32_bf16 v[84:87], v[120:123], v[72:75], v[84:87]
    v_mfma_f32_16x16x32_bf16 v[100:103], v[88:91], v[104:107], v[100:103]
    v_mfma_f32_16x16x32_bf16 v[116:119], v[120:123], v[104:107], v[116:119]
    v_mfma_f32_16x16x32_bf16 v[132:135], v[152:155], v[104:107], v[132:135]
    v_mfma_f32_16x16x32_bf16 v[148:151], v[120:123], v[136:139], v[148:151]
    v_mfma_f32_16x16x32_bf16 v[164:167], v[152:155], v[136:139], v[164:167]
    v_mfma_f32_16x16x32_bf16 v[180:183], v[184:187], v[136:139], v[180:183]
    v_mfma_f32_16x16x32_bf16 v[196:199], v[152:155], v[168:171], v[196:199]
    v_mfma_f32_16x16x32_bf16 v[212:215], v[184:187], v[168:171], v[212:215]
    v_mfma_f32_16x16x32_bf16 v[224:227], v[216:219], v[168:171], v[224:227]
    v_mfma_f32_16x16x32_bf16 v[228:231], v[184:187], v[200:203], v[228:231]
    v_mfma_f32_16x16x32_bf16 v[232:235], v[216:219], v[200:203], v[232:235]
    v_mfma_f32_16x16x32_bf16 v[236:239], v[48:51], v[72:75], v[236:239]
    v_mfma_f32_16x16x32_bf16 v[240:243], v[48:51], v[104:107], v[240:243]
    v_mfma_f32_16x16x32_bf16 v[244:247], v[48:51], v[136:139], v[244:247]
    v_mfma_f32_16x16x32_bf16 v[248:251], v[48:51], v[168:171], v[248:251]
    v_mfma_f32_16x16x32_bf16 v[252:255], v[48:51], v[200:203], v[252:255]
    s_lshl_b32 s68, s45, 1
    s_add_u32 s68, s68, s44
    s_mul_i32 s68, s68, 18432
    v_lshlrev_b32 v8, 4, v1
    v_add_u32 v8, s68, v8
    s_movk_i32 s85, 20000
K1_KV_POLL:
    s_waitcnt vmcnt(0)
    v_readfirstlane_b32 s69, v10
    s_cmp_ge_u32 s69, 128
    s_cbranch_scc1 K1_KV_POLL_OK
    s_sub_u32 s85, s85, 1
    s_cmp_eq_u32 s85, 0
    s_cbranch_scc1 K1_KV_POLL_OK
    buffer_load_dword v10, v9, s[52:55], 0 offen sc0 sc1
    s_branch K1_KV_POLL
K1_KV_POLL_OK:
    s_nop 3
    ds_write_b128 v8, v[68:71] offset:0
    ds_write_b128 v8, v[84:87] offset:1024
    ds_write_b128 v8, v[100:103] offset:2048
    ds_write_b128 v8, v[116:119] offset:3072
    ds_write_b128 v8, v[132:135] offset:4096
    ds_write_b128 v8, v[148:151] offset:5120
    ds_write_b128 v8, v[164:167] offset:6144
    ds_write_b128 v8, v[180:183] offset:7168
    ds_write_b128 v8, v[196:199] offset:8192
    ds_write_b128 v8, v[212:215] offset:9216
    ds_write_b128 v8, v[224:227] offset:10240
    ds_write_b128 v8, v[228:231] offset:11264
    ds_write_b128 v8, v[232:235] offset:12288
    ds_write_b128 v8, v[236:239] offset:13312
    ds_write_b128 v8, v[240:243] offset:14336
    ds_write_b128 v8, v[244:247] offset:15360
    ds_write_b128 v8, v[248:251] offset:16384
    ds_write_b128 v8, v[252:255] offset:17408
    s_mul_i32 s68, s45, 36864
    v_lshlrev_b32 v8, 2, v1
    v_add_u32 v9, s68, v8
    v_lshl_add_u32 v10, v1, 4, s68
    s_sub_u32 s68, s43, 9
    s_mul_i32 s69, s68, 26
    s_mul_i32 s70, s45, 13
    s_add_u32 s69, s69, s70
    s_lshl_b32 s69, s69, 10
    s_add_u32 s69, s69, 0xe00000
    s_lshl_b32 s68, s68, 1
    s_add_u32 s68, s68, s45
    s_mul_i32 s68, s68, 320
    s_add_u32 s68, s68, 0xe1a000
    s_waitcnt lgkmcnt(0)
    s_barrier
    s_cmp_eq_u32 s44, 0
    s_cbranch_scc0 K1_KV_R1
    ds_read2st64_b32 v[16:17], v9 offset0:0 offset1:72
    ds_read2st64_b32 v[18:19], v9 offset0:1 offset1:73
    ds_read2st64_b32 v[20:21], v9 offset0:2 offset1:74
    ds_read2st64_b32 v[22:23], v9 offset0:3 offset1:75
    ds_read2st64_b32 v[24:25], v9 offset0:4 offset1:76
    ds_read2st64_b32 v[26:27], v9 offset0:8 offset1:80
    ds_read2st64_b32 v[28:29], v9 offset0:9 offset1:81
    ds_read2st64_b32 v[30:31], v9 offset0:10 offset1:82
    ds_read2st64_b32 v[32:33], v9 offset0:11 offset1:83
    ds_read2st64_b32 v[34:35], v9 offset0:12 offset1:84
    ds_read2st64_b32 v[36:37], v9 offset0:13 offset1:85
    ds_read2st64_b32 v[38:39], v9 offset0:14 offset1:86
    ds_read2st64_b32 v[40:41], v9 offset0:15 offset1:87
    ds_read2st64_b32 v[42:43], v9 offset0:16 offset1:88
    ds_read2st64_b32 v[44:45], v9 offset0:17 offset1:89
    ds_read2st64_b32 v[46:47], v9 offset0:21 offset1:93
    ds_read2st64_b32 v[48:49], v9 offset0:22 offset1:94
    ds_read2st64_b32 v[50:51], v9 offset0:23 offset1:95
    ds_read2st64_b32 v[52:53], v9 offset0:24 offset1:96
    ds_read2st64_b32 v[54:55], v9 offset0:25 offset1:97
    ds_read2st64_b32 v[56:57], v9 offset0:26 offset1:98
    ds_read2st64_b32 v[58:59], v9 offset0:27 offset1:99
    s_waitcnt lgkmcnt(15)
    v_add_f32 v16, v16, v17
    s_mov_b32 exec_lo, 0xffffffff
    s_mov_b32 exec_hi, 0xffffffff
    s_add_u32 s70, s69, 0
    buffer_atomic_add_f32 v16, v8, s[36:39], s70 offen offset:0
    s_mov_b64 exec, -1
    s_waitcnt lgkmcnt(15)
    v_add_f32 v18, v18, v19
    s_mov_b32 exec_lo, 0xffffffff
    s_mov_b32 exec_hi, 0xffffffff
    s_add_u32 s70, s69, 0
    buffer_atomic_add_f32 v18, v8, s[36:39], s70 offen offset:256
    s_mov_b64 exec, -1
    s_waitcnt lgkmcnt(15)
    v_add_f32 v20, v20, v21
    s_mov_b32 exec_lo, 0xffffffff
    s_mov_b32 exec_hi, 0xffffffff
    s_add_u32 s70, s69, 0
    buffer_atomic_add_f32 v20, v8, s[36:39], s70 offen offset:512
    s_mov_b64 exec, -1
    s_waitcnt lgkmcnt(15)
    v_add_f32 v22, v22, v23
    s_mov_b32 exec_lo, 0xffffffff
    s_mov_b32 exec_hi, 0xffffffff
    s_add_u32 s70, s69, 0
    buffer_atomic_add_f32 v22, v8, s[36:39], s70 offen offset:768
    s_mov_b64 exec, -1
    s_waitcnt lgkmcnt(15)
    v_add_f32 v24, v24, v25
    s_mov_b32 exec_lo, 0xffffffff
    s_mov_b32 exec_hi, 0xffffffff
    s_add_u32 s70, s69, 0
    buffer_atomic_add_f32 v24, v8, s[36:39], s70 offen offset:1024
    s_mov_b64 exec, -1
    s_waitcnt lgkmcnt(15)
    v_add_f32 v26, v26, v27
    s_mov_b32 exec_lo, 0xffff
    s_mov_b32 exec_hi, 0x0
    s_add_u32 s70, s69, 0
    buffer_atomic_add_f32 v26, v8, s[36:39], s70 offen offset:2048
    s_mov_b64 exec, -1
    s_waitcnt lgkmcnt(15)
    v_add_f32 v28, v28, v29
    s_mov_b32 exec_lo, 0xffff
    s_mov_b32 exec_hi, 0x0
    s_add_u32 s70, s69, 0
    buffer_atomic_add_f32 v28, v8, s[36:39], s70 offen offset:2304
    s_mov_b64 exec, -1
    s_waitcnt lgkmcnt(14)
    v_add_f32 v30, v30, v31
    s_mov_b32 exec_lo, 0xffff
    s_mov_b32 exec_hi, 0x0
    s_add_u32 s70, s69, 0
    buffer_atomic_add_f32 v30, v8, s[36:39], s70 offen offset:2560
    s_mov_b64 exec, -1
    s_waitcnt lgkmcnt(13)
    v_add_f32 v32, v32, v33
    s_mov_b32 exec_lo, 0xffff
    s_mov_b32 exec_hi, 0x0
    s_add_u32 s70, s69, 0
    buffer_atomic_add_f32 v32, v8, s[36:39], s70 offen offset:2816
    s_mov_b64 exec, -1
    s_waitcnt lgkmcnt(12)
    v_add_f32 v34, v34, v35
    s_mov_b32 exec_lo, 0xffff
    s_mov_b32 exec_hi, 0x0
    s_add_u32 s70, s69, 0
    buffer_atomic_add_f32 v34, v8, s[36:39], s70 offen offset:3072
    s_mov_b64 exec, -1
    s_waitcnt lgkmcnt(11)
    v_add_f32 v36, v36, v37
    s_mov_b32 exec_lo, 0xffff0000
    s_mov_b32 exec_hi, 0xffffffff
    s_add_u32 s70, s69, 0
    buffer_atomic_add_f32 v36, v8, s[36:39], s70 offen offset:3328
    s_mov_b64 exec, -1
    s_waitcnt lgkmcnt(10)
    v_add_f32 v38, v38, v39
    s_mov_b32 exec_lo, 0xffff0000
    s_mov_b32 exec_hi, 0xffffffff
    s_add_u32 s70, s69, 0
    buffer_atomic_add_f32 v38, v8, s[36:39], s70 offen offset:3584
    s_mov_b64 exec, -1
    s_waitcnt lgkmcnt(9)
    v_add_f32 v40, v40, v41
    s_mov_b32 exec_lo, 0xffff0000
    s_mov_b32 exec_hi, 0xffffffff
    s_add_u32 s70, s69, 0
    buffer_atomic_add_f32 v40, v8, s[36:39], s70 offen offset:3840
    s_mov_b64 exec, -1
    s_waitcnt lgkmcnt(8)
    v_add_f32 v42, v42, v43
    s_mov_b32 exec_lo, 0xffff0000
    s_mov_b32 exec_hi, 0xffffffff
    s_add_u32 s70, s69, 4096
    buffer_atomic_add_f32 v42, v8, s[36:39], s70 offen offset:0
    s_mov_b64 exec, -1
    s_waitcnt lgkmcnt(7)
    v_add_f32 v44, v44, v45
    s_mov_b32 exec_lo, 0xffff0000
    s_mov_b32 exec_hi, 0xffffffff
    s_add_u32 s70, s69, 4096
    buffer_atomic_add_f32 v44, v8, s[36:39], s70 offen offset:256
    s_mov_b64 exec, -1
    s_waitcnt lgkmcnt(6)
    v_add_f32 v46, v46, v47
    s_mov_b32 exec_lo, 0xffffffff
    s_mov_b32 exec_hi, 0x0
    s_add_u32 s70, s69, 4096
    buffer_atomic_add_f32 v46, v8, s[36:39], s70 offen offset:1280
    s_mov_b64 exec, -1
    s_waitcnt lgkmcnt(5)
    v_add_f32 v48, v48, v49
    s_mov_b32 exec_lo, 0xffffffff
    s_mov_b32 exec_hi, 0x0
    s_add_u32 s70, s69, 4096
    buffer_atomic_add_f32 v48, v8, s[36:39], s70 offen offset:1536
    s_mov_b64 exec, -1
    s_waitcnt lgkmcnt(4)
    v_add_f32 v50, v50, v51
    s_mov_b32 exec_lo, 0xffffffff
    s_mov_b32 exec_hi, 0x0
    s_add_u32 s70, s69, 4096
    buffer_atomic_add_f32 v50, v8, s[36:39], s70 offen offset:1792
    s_mov_b64 exec, -1
    s_waitcnt lgkmcnt(3)
    v_add_f32 v52, v52, v53
    s_mov_b32 exec_lo, 0xffffffff
    s_mov_b32 exec_hi, 0x0
    s_add_u32 s70, s69, 4096
    buffer_atomic_add_f32 v52, v8, s[36:39], s70 offen offset:2048
    s_mov_b64 exec, -1
    s_waitcnt lgkmcnt(2)
    v_add_f32 v54, v54, v55
    s_mov_b32 exec_lo, 0xffffffff
    s_mov_b32 exec_hi, 0x0
    s_add_u32 s70, s69, 4096
    buffer_atomic_add_f32 v54, v8, s[36:39], s70 offen offset:2304
    s_mov_b64 exec, -1
    s_waitcnt lgkmcnt(1)
    v_add_f32 v56, v56, v57
    s_mov_b32 exec_lo, 0x0
    s_mov_b32 exec_hi, 0xffffffff
    s_add_u32 s70, s69, 4096
    buffer_atomic_add_f32 v56, v8, s[36:39], s70 offen offset:2560
    s_mov_b64 exec, -1
    s_waitcnt lgkmcnt(0)
    v_add_f32 v58, v58, v59
    s_mov_b32 exec_lo, 0x0
    s_mov_b32 exec_hi, 0xffffffff
    s_add_u32 s70, s69, 4096
    buffer_atomic_add_f32 v58, v8, s[36:39], s70 offen offset:2816
    s_mov_b64 exec, -1
    s_endpgm
K1_KV_R1:
    ds_read2st64_b32 v[16:17], v9 offset0:28 offset1:100
    ds_read2st64_b32 v[18:19], v9 offset0:29 offset1:101
    ds_read2st64_b32 v[20:21], v9 offset0:30 offset1:102
    ds_read2st64_b32 v[22:23], v9 offset0:34 offset1:106
    ds_read2st64_b32 v[24:25], v9 offset0:35 offset1:107
    ds_read2st64_b32 v[26:27], v9 offset0:36 offset1:108
    ds_read2st64_b32 v[28:29], v9 offset0:37 offset1:109
    ds_read2st64_b32 v[30:31], v9 offset0:38 offset1:110
    ds_read2st64_b32 v[32:33], v9 offset0:39 offset1:111
    ds_read2st64_b32 v[34:35], v9 offset0:40 offset1:112
    ds_read2st64_b32 v[36:37], v9 offset0:41 offset1:113
    ds_read2st64_b32 v[38:39], v9 offset0:42 offset1:114
    ds_read2st64_b32 v[40:41], v9 offset0:43 offset1:115
    ds_read2st64_b32 v[42:43], v9 offset0:47 offset1:119
    ds_read2st64_b32 v[44:45], v9 offset0:48 offset1:120
    ds_read2st64_b32 v[46:47], v9 offset0:49 offset1:121
    ds_read2st64_b32 v[48:49], v9 offset0:50 offset1:122
    ds_read2st64_b32 v[50:51], v9 offset0:51 offset1:123
    ds_read2st64_b32 v[52:53], v10 offset0:52 offset1:124
    ds_read2st64_b32 v[54:55], v10 offset0:56 offset1:128
    ds_read2st64_b32 v[56:57], v10 offset0:60 offset1:132
    ds_read2st64_b32 v[58:59], v10 offset0:64 offset1:136
    ds_read2st64_b32 v[60:61], v10 offset0:68 offset1:140
    s_waitcnt lgkmcnt(15)
    v_add_f32 v16, v16, v17
    s_mov_b32 exec_lo, 0x0
    s_mov_b32 exec_hi, 0xffffffff
    s_add_u32 s70, s69, 4096
    buffer_atomic_add_f32 v16, v8, s[36:39], s70 offen offset:3072
    s_mov_b64 exec, -1
    s_waitcnt lgkmcnt(15)
    v_add_f32 v18, v18, v19
    s_mov_b32 exec_lo, 0x0
    s_mov_b32 exec_hi, 0xffffffff
    s_add_u32 s70, s69, 4096
    buffer_atomic_add_f32 v18, v8, s[36:39], s70 offen offset:3328
    s_mov_b64 exec, -1
    s_waitcnt lgkmcnt(15)
    v_add_f32 v20, v20, v21
    s_mov_b32 exec_lo, 0x0
    s_mov_b32 exec_hi, 0xffffffff
    s_add_u32 s70, s69, 4096
    buffer_atomic_add_f32 v20, v8, s[36:39], s70 offen offset:3584
    s_mov_b64 exec, -1
    s_waitcnt lgkmcnt(15)
    v_add_f32 v22, v22, v23
    s_mov_b32 exec_lo, 0xffffffff
    s_mov_b32 exec_hi, 0xffff
    s_add_u32 s70, s69, 8192
    buffer_atomic_add_f32 v22, v8, s[36:39], s70 offen offset:512
    s_mov_b64 exec, -1
    s_waitcnt lgkmcnt(15)
    v_add_f32 v24, v24, v25
    s_mov_b32 exec_lo, 0xffffffff
    s_mov_b32 exec_hi, 0xffff
    s_add_u32 s70, s69, 8192
    buffer_atomic_add_f32 v24, v8, s[36:39], s70 offen offset:768
    s_mov_b64 exec, -1
    s_waitcnt lgkmcnt(15)
    v_add_f32 v26, v26, v27
    s_mov_b32 exec_lo, 0xffffffff
    s_mov_b32 exec_hi, 0xffff
    s_add_u32 s70, s69, 8192
    buffer_atomic_add_f32 v26, v8, s[36:39], s70 offen offset:1024
    s_mov_b64 exec, -1
    s_waitcnt lgkmcnt(15)
    v_add_f32 v28, v28, v29
    s_mov_b32 exec_lo, 0xffffffff
    s_mov_b32 exec_hi, 0xffff
    s_add_u32 s70, s69, 8192
    buffer_atomic_add_f32 v28, v8, s[36:39], s70 offen offset:1280
    s_mov_b64 exec, -1
    s_waitcnt lgkmcnt(15)
    v_add_f32 v30, v30, v31
    s_mov_b32 exec_lo, 0xffffffff
    s_mov_b32 exec_hi, 0xffff
    s_add_u32 s70, s69, 8192
    buffer_atomic_add_f32 v30, v8, s[36:39], s70 offen offset:1536
    s_mov_b64 exec, -1
    s_waitcnt lgkmcnt(14)
    v_add_f32 v32, v32, v33
    s_mov_b32 exec_lo, 0x0
    s_mov_b32 exec_hi, 0xffff0000
    s_add_u32 s70, s69, 8192
    buffer_atomic_add_f32 v32, v8, s[36:39], s70 offen offset:1792
    s_mov_b64 exec, -1
    s_waitcnt lgkmcnt(13)
    v_add_f32 v34, v34, v35
    s_mov_b32 exec_lo, 0x0
    s_mov_b32 exec_hi, 0xffff0000
    s_add_u32 s70, s69, 8192
    buffer_atomic_add_f32 v34, v8, s[36:39], s70 offen offset:2048
    s_mov_b64 exec, -1
    s_waitcnt lgkmcnt(12)
    v_add_f32 v36, v36, v37
    s_mov_b32 exec_lo, 0x0
    s_mov_b32 exec_hi, 0xffff0000
    s_add_u32 s70, s69, 8192
    buffer_atomic_add_f32 v36, v8, s[36:39], s70 offen offset:2304
    s_mov_b64 exec, -1
    s_waitcnt lgkmcnt(11)
    v_add_f32 v38, v38, v39
    s_mov_b32 exec_lo, 0x0
    s_mov_b32 exec_hi, 0xffff0000
    s_add_u32 s70, s69, 8192
    buffer_atomic_add_f32 v38, v8, s[36:39], s70 offen offset:2560
    s_mov_b64 exec, -1
    s_waitcnt lgkmcnt(10)
    v_add_f32 v40, v40, v41
    s_mov_b32 exec_lo, 0x0
    s_mov_b32 exec_hi, 0xffff0000
    s_add_u32 s70, s69, 8192
    buffer_atomic_add_f32 v40, v8, s[36:39], s70 offen offset:2816
    s_mov_b64 exec, -1
    s_waitcnt lgkmcnt(9)
    v_add_f32 v42, v42, v43
    s_mov_b32 exec_lo, 0xffffffff
    s_mov_b32 exec_hi, 0xffffffff
    s_add_u32 s70, s69, 8192
    buffer_atomic_add_f32 v42, v8, s[36:39], s70 offen offset:3840
    s_mov_b64 exec, -1
    s_waitcnt lgkmcnt(8)
    v_add_f32 v44, v44, v45
    s_mov_b32 exec_lo, 0xffffffff
    s_mov_b32 exec_hi, 0xffffffff
    s_add_u32 s70, s69, 12288
    buffer_atomic_add_f32 v44, v8, s[36:39], s70 offen offset:0
    s_mov_b64 exec, -1
    s_waitcnt lgkmcnt(7)
    v_add_f32 v46, v46, v47
    s_mov_b32 exec_lo, 0xffffffff
    s_mov_b32 exec_hi, 0xffffffff
    s_add_u32 s70, s69, 12288
    buffer_atomic_add_f32 v46, v8, s[36:39], s70 offen offset:256
    s_mov_b64 exec, -1
    s_waitcnt lgkmcnt(6)
    v_add_f32 v48, v48, v49
    s_mov_b32 exec_lo, 0xffffffff
    s_mov_b32 exec_hi, 0xffffffff
    s_add_u32 s70, s69, 12288
    buffer_atomic_add_f32 v48, v8, s[36:39], s70 offen offset:512
    s_mov_b64 exec, -1
    s_waitcnt lgkmcnt(5)
    v_add_f32 v50, v50, v51
    s_mov_b32 exec_lo, 0xffffffff
    s_mov_b32 exec_hi, 0xffffffff
    s_add_u32 s70, s69, 12288
    buffer_atomic_add_f32 v50, v8, s[36:39], s70 offen offset:768
    s_mov_b64 exec, -1
    s_waitcnt lgkmcnt(4)
    v_add_f32 v52, v52, v53
    s_mov_b32 exec_lo, 0xffff
    s_mov_b32 exec_hi, 0x0
    buffer_atomic_add_f32 v52, v8, s[36:39], s68 offen offset:0
    s_mov_b64 exec, -1
    s_waitcnt lgkmcnt(3)
    v_add_f32 v54, v54, v55
    s_mov_b32 exec_lo, 0xffff
    s_mov_b32 exec_hi, 0x0
    buffer_atomic_add_f32 v54, v8, s[36:39], s68 offen offset:64
    s_mov_b64 exec, -1
    s_waitcnt lgkmcnt(2)
    v_add_f32 v56, v56, v57
    s_mov_b32 exec_lo, 0xffff
    s_mov_b32 exec_hi, 0x0
    buffer_atomic_add_f32 v56, v8, s[36:39], s68 offen offset:128
    s_mov_b64 exec, -1
    s_waitcnt lgkmcnt(1)
    v_add_f32 v58, v58, v59
    s_mov_b32 exec_lo, 0xffff
    s_mov_b32 exec_hi, 0x0
    buffer_atomic_add_f32 v58, v8, s[36:39], s68 offen offset:192
    s_mov_b64 exec, -1
    s_waitcnt lgkmcnt(0)
    v_add_f32 v60, v60, v61
    s_mov_b32 exec_lo, 0xffff
    s_mov_b32 exec_hi, 0x0
    buffer_atomic_add_f32 v60, v8, s[36:39], s68 offen offset:256
    s_mov_b64 exec, -1
    s_endpgm
K1_PREP:
    s_waitcnt lgkmcnt(0)
    s_mov_b32 s28, s4
    s_mov_b32 s29, s5
    s_mov_b32 s30, 0x280000
    s_mov_b32 s31, 0x00020000
    s_mov_b32 s36, s24
    s_mov_b32 s37, s25
    s_mov_b32 s38, 0x10000000
    s_mov_b32 s39, 0x00020000
    s_mov_b32 s48, s18
    s_mov_b32 s49, s19
    s_mov_b32 s50, 0x500
    s_mov_b32 s51, 0x00020000
    s_mov_b32 s52, s22
    s_mov_b32 s53, s23
    s_mov_b32 s54, 0x100
    s_mov_b32 s55, 0x00020000
    s_mov_b32 s56, s16
    s_mov_b32 s57, s17
    s_mov_b32 s58, 0x21c000
    s_mov_b32 s59, 0x00020000
    s_mov_b32 s60, s8
    s_mov_b32 s61, s9
    s_mov_b32 s62, 0xc8000
    s_mov_b32 s63, 0x00020000
    s_lshl_b32 s44, s42, 3
    s_add_u32 s44, s44, s26
    v_mov_b32 v4, 0
    v_mov_b32 v5, 0
    v_mov_b32 v6, 0
    v_mov_b32 v7, 0
    v_lshlrev_b32 v8, 4, v1
    s_cmp_lt_u32 s44, 109
    s_cbranch_scc0 K1_PREP_NZ
    s_lshl_b32 s45, s44, 10
    s_add_u32 s45, s45, 0xe00000
    buffer_store_dwordx4 v[4:7], v8, s[36:39], s45 offen sc0 sc1
    s_waitcnt vmcnt(0)
K1_PREP_NZ:
    v_mov_b32 v9, 0
    v_mov_b32 v10, 1
    s_mov_b64 exec, 1
    buffer_atomic_add v10, v9, s[52:55], 0 offen sc1
    s_mov_b64 exec, -1
    v_lshrrev_b32 v2, 3, v1
    v_mul_u32_u24 v2, 1280, v2
    v_and_b32 v3, 7, v1
    v_lshl_add_u32 v10, v3, 4, v2
    v_add_u32 v11, 10240, v10
    v_add_u32 v12, 20480, v10
    v_add_u32 v13, 30720, v10
    v_lshrrev_b32 v2, 4, v1
    v_and_b32 v3, 15, v1
    v_lshrrev_b32 v3, 2, v3
    v_lshl_add_u32 v2, v2, 2, v3
    v_lshlrev_b32 v2, 7, v2
    v_and_b32 v3, 3, v1
    v_lshl_add_u32 v14, v3, 3, v2
    s_mul_i32 s46, s26, 12288
    v_add_u32 v14, s46, v14
    s_add_u32 s64, s44, 0
    s_cmp_lt_u32 s64, 540
    s_cselect_b32 s64, s64, 0
    s_cselect_b32 s80, 1, 0
    s_mul_hi_u32 s68, s64, 429496730
    s_mul_i32 s72, s68, 10
    s_sub_u32 s64, s64, s72
    s_mul_i32 s72, s68, 40960
    s_lshl_b32 s73, s64, 7
    s_add_u32 s72, s72, s73
    s_add_u32 m0, s46, 0
    s_nop 0
    buffer_load_dwordx4 v10, s[56:59], s72 offen lds
    s_add_u32 m0, s46, 1024
    s_nop 0
    buffer_load_dwordx4 v11, s[56:59], s72 offen lds
    s_add_u32 m0, s46, 2048
    s_nop 0
    buffer_load_dwordx4 v12, s[56:59], s72 offen lds
    s_add_u32 m0, s46, 3072
    s_nop 0
    buffer_load_dwordx4 v13, s[56:59], s72 offen lds
    s_add_u32 s65, s44, 128
    s_cmp_lt_u32 s65, 540
    s_cselect_b32 s65, s65, 0
    s_cselect_b32 s81, 1, 0
    s_mul_hi_u32 s69, s65, 429496730
    s_mul_i32 s72, s69, 10
    s_sub_u32 s65, s65, s72
    s_mul_i32 s72, s69, 40960
    s_lshl_b32 s73, s65, 7
    s_add_u32 s72, s72, s73
    s_add_u32 m0, s46, 4096
    s_nop 0
    buffer_load_dwordx4 v10, s[56:59], s72 offen lds
    s_add_u32 m0, s46, 5120
    s_nop 0
    buffer_load_dwordx4 v11, s[56:59], s72 offen lds
    s_add_u32 m0, s46, 6144
    s_nop 0
    buffer_load_dwordx4 v12, s[56:59], s72 offen lds
    s_add_u32 m0, s46, 7168
    s_nop 0
    buffer_load_dwordx4 v13, s[56:59], s72 offen lds
    s_add_u32 s66, s44, 256
    s_cmp_lt_u32 s66, 540
    s_cselect_b32 s66, s66, 0
    s_cselect_b32 s82, 1, 0
    s_mul_hi_u32 s70, s66, 429496730
    s_mul_i32 s72, s70, 10
    s_sub_u32 s66, s66, s72
    s_mul_i32 s72, s70, 40960
    s_lshl_b32 s73, s66, 7
    s_add_u32 s72, s72, s73
    s_add_u32 m0, s46, 8192
    s_nop 0
    buffer_load_dwordx4 v10, s[56:59], s72 offen lds
    s_add_u32 m0, s46, 9216
    s_nop 0
    buffer_load_dwordx4 v11, s[56:59], s72 offen lds
    s_add_u32 m0, s46, 10240
    s_nop 0
    buffer_load_dwordx4 v12, s[56:59], s72 offen lds
    s_add_u32 m0, s46, 11264
    s_nop 0
    buffer_load_dwordx4 v13, s[56:59], s72 offen lds
    s_waitcnt vmcnt(8)
    ds_read_b64_tr_b16 v[16:17], v14 offset:0
    ds_read_b64_tr_b16 v[18:19], v14 offset:2048
    ds_read_b64_tr_b16 v[20:21], v14 offset:32
    ds_read_b64_tr_b16 v[22:23], v14 offset:2080
    ds_read_b64_tr_b16 v[24:25], v14 offset:64
    ds_read_b64_tr_b16 v[26:27], v14 offset:2112
    ds_read_b64_tr_b16 v[28:29], v14 offset:96
    ds_read_b64_tr_b16 v[30:31], v14 offset:2144
    s_lshl_b32 s72, s64, 2
    s_mul_i32 s72, s72, 54
    s_add_u32 s72, s72, s68
    s_lshl_b32 s72, s72, 10
    s_add_u32 s72, s72, 0xa00000
    s_cmp_eq_u32 s80, 1
    s_cselect_b32 s72, s72, 0xf00000
    s_waitcnt lgkmcnt(0)
    buffer_store_dwordx4 v[16:19], v8, s[36:39], s72 offen sc0 sc1
    s_add_u32 s72, s72, 55296
    buffer_store_dwordx4 v[20:23], v8, s[36:39], s72 offen sc0 sc1
    s_add_u32 s72, s72, 55296
    buffer_store_dwordx4 v[24:27], v8, s[36:39], s72 offen sc0 sc1
    s_add_u32 s72, s72, 55296
    buffer_store_dwordx4 v[28:31], v8, s[36:39], s72 offen sc0 sc1
    s_nop 1
    s_waitcnt vmcnt(8)
    ds_read_b64_tr_b16 v[16:17], v14 offset:4096
    ds_read_b64_tr_b16 v[18:19], v14 offset:6144
    ds_read_b64_tr_b16 v[20:21], v14 offset:4128
    ds_read_b64_tr_b16 v[22:23], v14 offset:6176
    ds_read_b64_tr_b16 v[24:25], v14 offset:4160
    ds_read_b64_tr_b16 v[26:27], v14 offset:6208
    ds_read_b64_tr_b16 v[28:29], v14 offset:4192
    ds_read_b64_tr_b16 v[30:31], v14 offset:6240
    s_lshl_b32 s72, s65, 2
    s_mul_i32 s72, s72, 54
    s_add_u32 s72, s72, s69
    s_lshl_b32 s72, s72, 10
    s_add_u32 s72, s72, 0xa00000
    s_cmp_eq_u32 s81, 1
    s_cselect_b32 s72, s72, 0xf00000
    s_waitcnt lgkmcnt(0)
    buffer_store_dwordx4 v[16:19], v8, s[36:39], s72 offen sc0 sc1
    s_add_u32 s72, s72, 55296
    buffer_store_dwordx4 v[20:23], v8, s[36:39], s72 offen sc0 sc1
    s_add_u32 s72, s72, 55296
    buffer_store_dwordx4 v[24:27], v8, s[36:39], s72 offen sc0 sc1
    s_add_u32 s72, s72, 55296
    buffer_store_dwordx4 v[28:31], v8, s[36:39], s72 offen sc0 sc1
    s_nop 1
    s_waitcnt vmcnt(8)
    ds_read_b64_tr_b16 v[16:17], v14 offset:8192
    ds_read_b64_tr_b16 v[18:19], v14 offset:10240
    ds_read_b64_tr_b16 v[20:21], v14 offset:8224
    ds_read_b64_tr_b16 v[22:23], v14 offset:10272
    ds_read_b64_tr_b16 v[24:25], v14 offset:8256
    ds_read_b64_tr_b16 v[26:27], v14 offset:10304
    ds_read_b64_tr_b16 v[28:29], v14 offset:8288
    ds_read_b64_tr_b16 v[30:31], v14 offset:10336
    s_lshl_b32 s72, s66, 2
    s_mul_i32 s72, s72, 54
    s_add_u32 s72, s72, s70
    s_lshl_b32 s72, s72, 10
    s_add_u32 s72, s72, 0xa00000
    s_cmp_eq_u32 s82, 1
    s_cselect_b32 s72, s72, 0xf00000
    s_waitcnt lgkmcnt(0)
    buffer_store_dwordx4 v[16:19], v8, s[36:39], s72 offen sc0 sc1
    s_add_u32 s72, s72, 55296
    buffer_store_dwordx4 v[20:23], v8, s[36:39], s72 offen sc0 sc1
    s_add_u32 s72, s72, 55296
    buffer_store_dwordx4 v[24:27], v8, s[36:39], s72 offen sc0 sc1
    s_add_u32 s72, s72, 55296
    buffer_store_dwordx4 v[28:31], v8, s[36:39], s72 offen sc0 sc1
    s_nop 1
    s_waitcnt vmcnt(0)
    s_add_u32 s64, s44, 384
    s_cmp_lt_u32 s64, 540
    s_cselect_b32 s64, s64, 0
    s_cselect_b32 s80, 1, 0
    s_mul_hi_u32 s68, s64, 429496730
    s_mul_i32 s72, s68, 10
    s_sub_u32 s64, s64, s72
    s_mul_i32 s72, s68, 40960
    s_lshl_b32 s73, s64, 7
    s_add_u32 s72, s72, s73
    s_add_u32 m0, s46, 0
    s_nop 0
    buffer_load_dwordx4 v10, s[56:59], s72 offen lds
    s_add_u32 m0, s46, 1024
    s_nop 0
    buffer_load_dwordx4 v11, s[56:59], s72 offen lds
    s_add_u32 m0, s46, 2048
    s_nop 0
    buffer_load_dwordx4 v12, s[56:59], s72 offen lds
    s_add_u32 m0, s46, 3072
    s_nop 0
    buffer_load_dwordx4 v13, s[56:59], s72 offen lds
    s_add_u32 s65, s44, 512
    s_cmp_lt_u32 s65, 540
    s_cselect_b32 s65, s65, 0
    s_cselect_b32 s81, 1, 0
    s_mul_hi_u32 s69, s65, 429496730
    s_mul_i32 s72, s69, 10
    s_sub_u32 s65, s65, s72
    s_mul_i32 s72, s69, 40960
    s_lshl_b32 s73, s65, 7
    s_add_u32 s72, s72, s73
    s_add_u32 m0, s46, 4096
    s_nop 0
    buffer_load_dwordx4 v10, s[56:59], s72 offen lds
    s_add_u32 m0, s46, 5120
    s_nop 0
    buffer_load_dwordx4 v11, s[56:59], s72 offen lds
    s_add_u32 m0, s46, 6144
    s_nop 0
    buffer_load_dwordx4 v12, s[56:59], s72 offen lds
    s_add_u32 m0, s46, 7168
    s_nop 0
    buffer_load_dwordx4 v13, s[56:59], s72 offen lds
    s_add_u32 s66, s44, 0
    s_cmp_lt_u32 s66, 200
    s_cselect_b32 s66, s66, 0
    s_cselect_b32 s82, 1, 0
    s_mul_hi_u32 s70, s66, 429496730
    s_mul_i32 s72, s70, 10
    s_sub_u32 s66, s66, s72
    s_mul_i32 s72, s70, 40960
    s_lshl_b32 s73, s66, 7
    s_add_u32 s72, s72, s73
    s_add_u32 m0, s46, 8192
    s_nop 0
    buffer_load_dwordx4 v10, s[60:63], s72 offen lds
    s_add_u32 m0, s46, 9216
    s_nop 0
    buffer_load_dwordx4 v11, s[60:63], s72 offen lds
    s_add_u32 m0, s46, 10240
    s_nop 0
    buffer_load_dwordx4 v12, s[60:63], s72 offen lds
    s_add_u32 m0, s46, 11264
    s_nop 0
    buffer_load_dwordx4 v13, s[60:63], s72 offen lds
    s_waitcnt vmcnt(8)
    ds_read_b64_tr_b16 v[16:17], v14 offset:0
    ds_read_b64_tr_b16 v[18:19], v14 offset:2048
    ds_read_b64_tr_b16 v[20:21], v14 offset:32
    ds_read_b64_tr_b16 v[22:23], v14 offset:2080
    ds_read_b64_tr_b16 v[24:25], v14 offset:64
    ds_read_b64_tr_b16 v[26:27], v14 offset:2112
    ds_read_b64_tr_b16 v[28:29], v14 offset:96
    ds_read_b64_tr_b16 v[30:31], v14 offset:2144
    s_lshl_b32 s72, s64, 2
    s_mul_i32 s72, s72, 54
    s_add_u32 s72, s72, s68
    s_lshl_b32 s72, s72, 10
    s_add_u32 s72, s72, 0xa00000
    s_cmp_eq_u32 s80, 1
    s_cselect_b32 s72, s72, 0xf00000
    s_waitcnt lgkmcnt(0)
    buffer_store_dwordx4 v[16:19], v8, s[36:39], s72 offen sc0 sc1
    s_add_u32 s72, s72, 55296
    buffer_store_dwordx4 v[20:23], v8, s[36:39], s72 offen sc0 sc1
    s_add_u32 s72, s72, 55296
    buffer_store_dwordx4 v[24:27], v8, s[36:39], s72 offen sc0 sc1
    s_add_u32 s72, s72, 55296
    buffer_store_dwordx4 v[28:31], v8, s[36:39], s72 offen sc0 sc1
    s_nop 1
    s_waitcnt vmcnt(8)
    ds_read_b64_tr_b16 v[16:17], v14 offset:4096
    ds_read_b64_tr_b16 v[18:19], v14 offset:6144
    ds_read_b64_tr_b16 v[20:21], v14 offset:4128
    ds_read_b64_tr_b16 v[22:23], v14 offset:6176
    ds_read_b64_tr_b16 v[24:25], v14 offset:4160
    ds_read_b64_tr_b16 v[26:27], v14 offset:6208
    ds_read_b64_tr_b16 v[28:29], v14 offset:4192
    ds_read_b64_tr_b16 v[30:31], v14 offset:6240
    s_lshl_b32 s72, s65, 2
    s_mul_i32 s72, s72, 54
    s_add_u32 s72, s72, s69
    s_lshl_b32 s72, s72, 10
    s_add_u32 s72, s72, 0xa00000
    s_cmp_eq_u32 s81, 1
    s_cselect_b32 s72, s72, 0xf00000
    s_waitcnt lgkmcnt(0)
    buffer_store_dwordx4 v[16:19], v8, s[36:39], s72 offen sc0 sc1
    s_add_u32 s72, s72, 55296
    buffer_store_dwordx4 v[20:23], v8, s[36:39], s72 offen sc0 sc1
    s_add_u32 s72, s72, 55296
    buffer_store_dwordx4 v[24:27], v8, s[36:39], s72 offen sc0 sc1
    s_add_u32 s72, s72, 55296
    buffer_store_dwordx4 v[28:31], v8, s[36:39], s72 offen sc0 sc1
    s_nop 1
    s_waitcnt vmcnt(8)
    ds_read_b64_tr_b16 v[16:17], v14 offset:8192
    ds_read_b64_tr_b16 v[18:19], v14 offset:10240
    ds_read_b64_tr_b16 v[20:21], v14 offset:8224
    ds_read_b64_tr_b16 v[22:23], v14 offset:10272
    ds_read_b64_tr_b16 v[24:25], v14 offset:8256
    ds_read_b64_tr_b16 v[26:27], v14 offset:10304
    ds_read_b64_tr_b16 v[28:29], v14 offset:8288
    ds_read_b64_tr_b16 v[30:31], v14 offset:10336
    s_lshl_b32 s72, s66, 2
    s_mul_i32 s72, s72, 20
    s_add_u32 s72, s72, s70
    s_lshl_b32 s72, s72, 10
    s_add_u32 s72, s72, 0xd00000
    s_cmp_eq_u32 s82, 1
    s_cselect_b32 s72, s72, 0xf00000
    s_waitcnt lgkmcnt(0)
    buffer_store_dwordx4 v[16:19], v8, s[36:39], s72 offen sc0 sc1
    s_add_u32 s72, s72, 20480
    buffer_store_dwordx4 v[20:23], v8, s[36:39], s72 offen sc0 sc1
    s_add_u32 s72, s72, 20480
    buffer_store_dwordx4 v[24:27], v8, s[36:39], s72 offen sc0 sc1
    s_add_u32 s72, s72, 20480
    buffer_store_dwordx4 v[28:31], v8, s[36:39], s72 offen sc0 sc1
    s_nop 1
    s_waitcnt vmcnt(0)
    s_add_u32 s64, s44, 128
    s_cmp_lt_u32 s64, 200
    s_cselect_b32 s64, s64, 0
    s_cselect_b32 s80, 1, 0
    s_mul_hi_u32 s68, s64, 429496730
    s_mul_i32 s72, s68, 10
    s_sub_u32 s64, s64, s72
    s_mul_i32 s72, s68, 40960
    s_lshl_b32 s73, s64, 7
    s_add_u32 s72, s72, s73
    s_add_u32 m0, s46, 0
    s_nop 0
    buffer_load_dwordx4 v10, s[60:63], s72 offen lds
    s_add_u32 m0, s46, 1024
    s_nop 0
    buffer_load_dwordx4 v11, s[60:63], s72 offen lds
    s_add_u32 m0, s46, 2048
    s_nop 0
    buffer_load_dwordx4 v12, s[60:63], s72 offen lds
    s_add_u32 m0, s46, 3072
    s_nop 0
    buffer_load_dwordx4 v13, s[60:63], s72 offen lds
    s_waitcnt vmcnt(0)
    ds_read_b64_tr_b16 v[16:17], v14 offset:0
    ds_read_b64_tr_b16 v[18:19], v14 offset:2048
    ds_read_b64_tr_b16 v[20:21], v14 offset:32
    ds_read_b64_tr_b16 v[22:23], v14 offset:2080
    ds_read_b64_tr_b16 v[24:25], v14 offset:64
    ds_read_b64_tr_b16 v[26:27], v14 offset:2112
    ds_read_b64_tr_b16 v[28:29], v14 offset:96
    ds_read_b64_tr_b16 v[30:31], v14 offset:2144
    s_lshl_b32 s72, s64, 2
    s_mul_i32 s72, s72, 20
    s_add_u32 s72, s72, s68
    s_lshl_b32 s72, s72, 10
    s_add_u32 s72, s72, 0xd00000
    s_cmp_eq_u32 s80, 1
    s_cselect_b32 s72, s72, 0xf00000
    s_waitcnt lgkmcnt(0)
    buffer_store_dwordx4 v[16:19], v8, s[36:39], s72 offen sc0 sc1
    s_add_u32 s72, s72, 20480
    buffer_store_dwordx4 v[20:23], v8, s[36:39], s72 offen sc0 sc1
    s_add_u32 s72, s72, 20480
    buffer_store_dwordx4 v[24:27], v8, s[36:39], s72 offen sc0 sc1
    s_add_u32 s72, s72, 20480
    buffer_store_dwordx4 v[28:31], v8, s[36:39], s72 offen sc0 sc1
    s_nop 1
    s_waitcnt vmcnt(0)
    v_mov_b32 v9, 4
    v_mov_b32 v10, 1
    s_mov_b64 exec, 1
    buffer_atomic_add v10, v9, s[52:55], 0 offen sc1
    s_mov_b64 exec, -1
K1_END:
    s_endpgm
.text
.globl k2_kernel
.p2align 8
.type k2_kernel,@function
k2_kernel:
    s_cmp_ge_u32 s2, 256
    s_cbranch_scc1 K2_END
    s_load_dwordx2 s[20:21], s[0:1], 64
    s_load_dwordx2 s[24:25], s[0:1], 80
    v_lshrrev_b32 v2, 6, v0
    v_and_b32 v1, 63, v0
    v_readfirstlane_b32 s26, v2
    s_and_b32 s40, s2, 7
    s_lshr_b32 s41, s2, 3
    s_and_b32 s42, s40, 3
    s_lshl_b32 s42, s42, 3
    s_and_b32 s43, s41, 7
    s_add_u32 s42, s42, s43
    s_lshr_b32 s43, s40, 2
    s_lshl_b32 s43, s43, 2
    s_lshr_b32 s44, s41, 3
    s_add_u32 s43, s43, s44
    v_lshlrev_b32 v2, 4, v1
    v_lshlrev_b32 v3, 2, v1
    v_and_b32 v4, 15, v1
    v_lshrrev_b32 v5, 4, v1
    s_lshl_b32 s45, s42, 2
    s_mul_i32 s46, s43, 5
    s_waitcnt lgkmcnt(0)
    s_mov_b32 s36, s24
    s_mov_b32 s37, s25
    s_mov_b32 s38, 0x10000000
    s_mov_b32 s39, 0x00020000
    s_mov_b32 s28, s20
    s_mov_b32 s29, s21
    s_mov_b32 s30, 0x280000
    s_mov_b32 s31, 0x00020000
    s_lshl_b32 s47, s45, 6
    s_add_u32 s47, s47, 0xe40000
    v_lshlrev_b32 v6, 2, v4
    s_cmp_ge_u32 s26, 4
    s_cbranch_scc1 K2_ATT
    s_getpc_b64 s[90:91]
PC_2:
    s_sub_u32 s90, s90, PC_2-k2_kernel
    s_subb_u32 s91, s91, 0
    v_and_b32 v7, 63, v0
    v_lshlrev_b32 v7, 7, v7
    s_lshl_b32 s92, s26, 13
    v_add_u32 v7, s92, v7
    v_min_u32 v9, K2_END-k2_kernel-4, v7
    global_load_dword v8, v9, s[90:91]
    buffer_load_dword v240, v6, s[36:39], s47 offen offset:0
    buffer_load_dword v241, v6, s[36:39], s47 offen offset:64
    buffer_load_dword v242, v6, s[36:39], s47 offen offset:128
    buffer_load_dword v243, v6, s[36:39], s47 offen offset:192
    s_mul_i32 s48, s26, 14
    s_cmp_eq_u32 s26, 3
    s_cselect_b32 s49, 1, 0
    s_sub_u32 s48, s48, s49
    s_cmp_ge_u32 s26, 2
    s_cselect_b32 s61, 13, 14
    s_lshr_b32 s49, s41, 3
    s_mul_i32 s49, s49, 14
    s_and_b32 s50, s41, 7
    s_mul_i32 s50, s50, 7
    s_add_u32 s49, s49, s50
    s_lshr_b32 s60, s49, 2
    s_mov_b32 s60, 0
    s_cmp_ge_u32 s60, s61
    s_cselect_b32 s49, s61, 0
    s_sub_u32 s60, s60, s49
    s_lshl_b32 s60, s60, 10
    s_lshl_b32 s61, s61, 10
    s_add_u32 s50, s45, 0
    s_mul_i32 s50, s50, 74
    s_add_u32 s50, s50, s48
    s_lshl_b32 s50, s50, 10
    v_add_u32 v244, s50, v2
    s_add_u32 s50, s45, 1
    s_mul_i32 s50, s50, 74
    s_add_u32 s50, s50, s48
    s_lshl_b32 s50, s50, 10
    v_add_u32 v245, s50, v2
    s_add_u32 s50, s45, 2
    s_mul_i32 s50, s50, 74
    s_add_u32 s50, s50, s48
    s_lshl_b32 s50, s50, 10
    v_add_u32 v246, s50, v2
    s_add_u32 s50, s45, 3
    s_mul_i32 s50, s50, 74
    s_add_u32 s50, s50, s48
    s_lshl_b32 s50, s50, 10
    v_add_u32 v247, s50, v2
    s_add_u32 s50, s46, 0
    s_mul_i32 s50, s50, 54
    s_add_u32 s50, s50, s48
    s_lshl_b32 s50, s50, 10
    s_add_u32 s50, s50, 0xa00000
    v_add_u32 v248, s50, v2
    s_add_u32 s50, s46, 1
    s_mul_i32 s50, s50, 54
    s_add_u32 s50, s50, s48
    s_lshl_b32 s50, s50, 10
    s_add_u32 s50, s50, 0xa00000
    v_add_u32 v249, s50, v2
    s_add_u32 s50, s46, 2
    s_mul_i32 s50, s50, 54
    s_add_u32 s50, s50, s48
    s_lshl_b32 s50, s50, 10
    s_add_u32 s50, s50, 0xa00000
    v_add_u32 v250, s50, v2
    s_add_u32 s50, s46, 3
    s_mul_i32 s50, s50, 54
    s_add_u32 s50, s50, s48
    s_lshl_b32 s50, s50, 10
    s_add_u32 s50, s50, 0xa00000
    v_add_u32 v251, s50, v2
    s_add_u32 s50, s46, 4
    s_mul_i32 s50, s50, 54
    s_add_u32 s50, s50, s48
    s_lshl_b32 s50, s50, 10
    s_add_u32 s50, s50, 0xa00000
    v_add_u32 v252, s50, v2
    s_cmp_ge_u32 s26, 2
    s_cbranch_scc1 K2_M_SK0
    buffer_load_dwordx4 v[112:115], v248, s[36:39], s60 offen
    buffer_load_dwordx4 v[116:119], v249, s[36:39], s60 offen
    buffer_load_dwordx4 v[120:123], v250, s[36:39], s60 offen
    buffer_load_dwordx4 v[124:127], v251, s[36:39], s60 offen
    buffer_load_dwordx4 v[128:131], v252, s[36:39], s60 offen
    buffer_load_dwordx4 v[96:99], v244, s[36:39], s60 offen
    buffer_load_dwordx4 v[100:103], v245, s[36:39], s60 offen
    buffer_load_dwordx4 v[104:107], v246, s[36:39], s60 offen
    buffer_load_dwordx4 v[108:111], v247, s[36:39], s60 offen
    s_add_u32 s60, s60, 1024
    s_cmp_eq_u32 s60, s61
    s_cselect_b32 s60, 0, s60
K2_M_SK0:
    buffer_load_dwordx4 v[148:151], v248, s[36:39], s60 offen
    buffer_load_dwordx4 v[152:155], v249, s[36:39], s60 offen
    buffer_load_dwordx4 v[156:159], v250, s[36:39], s60 offen
    buffer_load_dwordx4 v[160:163], v251, s[36:39], s60 offen
    buffer_load_dwordx4 v[164:167], v252, s[36:39], s60 offen
    buffer_load_dwordx4 v[132:135], v244, s[36:39], s60 offen
    buffer_load_dwordx4 v[136:139], v245, s[36:39], s60 offen
    buffer_load_dwordx4 v[140:143], v246, s[36:39], s60 offen
    buffer_load_dwordx4 v[144:147], v247, s[36:39], s60 offen
    s_add_u32 s60, s60, 1024
    s_cmp_eq_u32 s60, s61
    s_cselect_b32 s60, 0, s60
    buffer_load_dwordx4 v[184:187], v248, s[36:39], s60 offen
    buffer_load_dwordx4 v[188:191], v249, s[36:39], s60 offen
    buffer_load_dwordx4 v[192:195], v250, s[36:39], s60 offen
    buffer_load_dwordx4 v[196:199], v251, s[36:39], s60 offen
    buffer_load_dwordx4 v[200:203], v252, s[36:39], s60 offen
    buffer_load_dwordx4 v[168:171], v244, s[36:39], s60 offen
    buffer_load_dwordx4 v[172:175], v245, s[36:39], s60 offen
    buffer_load_dwordx4 v[176:179], v246, s[36:39], s60 offen
    buffer_load_dwordx4 v[180:183], v247, s[36:39], s60 offen
    s_add_u32 s60, s60, 1024
    s_cmp_eq_u32 s60, s61
    s_cselect_b32 s60, 0, s60
    v_mov_b32 v16, 0
    v_mov_b32 v17, 0
    v_mov_b32 v18, 0
    v_mov_b32 v19, 0
    v_mov_b32 v20, 0
    v_mov_b32 v21, 0
    v_mov_b32 v22, 0
    v_mov_b32 v23, 0
    v_mov_b32 v24, 0
    v_mov_b32 v25, 0
    v_mov_b32 v26, 0
    v_mov_b32 v27, 0
    v_mov_b32 v28, 0
    v_mov_b32 v29, 0
    v_mov_b32 v30, 0
    v_mov_b32 v31, 0
    v_mov_b32 v32, 0
    v_mov_b32 v33, 0
    v_mov_b32 v34, 0
    v_mov_b32 v35, 0
    v_mov_b32 v36, 0
    v_mov_b32 v37, 0
    v_mov_b32 v38, 0
    v_mov_b32 v39, 0
    v_mov_b32 v40, 0
    v_mov_b32 v41, 0
    v_mov_b32 v42, 0
    v_mov_b32 v43, 0
    v_mov_b32 v44, 0
    v_mov_b32 v45, 0
    v_mov_b32 v46, 0
    v_mov_b32 v47, 0
    v_mov_b32 v48, 0
    v_mov_b32 v49, 0
    v_mov_b32 v50, 0
    v_mov_b32 v51, 0
    v_mov_b32 v52, 0
    v_mov_b32 v53, 0
    v_mov_b32 v54, 0
    v_mov_b32 v55, 0
    v_mov_b32 v56, 0
    v_mov_b32 v57, 0
    v_mov_b32 v58, 0
    v_mov_b32 v59, 0
    v_mov_b32 v60, 0
    v_mov_b32 v61, 0
    v_mov_b32 v62, 0
    v_mov_b32 v63, 0
    v_mov_b32 v64, 0
    v_mov_b32 v65, 0
    v_mov_b32 v66, 0
    v_mov_b32 v67, 0
    v_mov_b32 v68, 0
    v_mov_b32 v69, 0
    v_mov_b32 v70, 0
    v_mov_b32 v71, 0
    v_mov_b32 v72, 0
    v_mov_b32 v73, 0
    v_mov_b32 v74, 0
    v_mov_b32 v75, 0
    v_mov_b32 v76, 0
    v_mov_b32 v77, 0
    v_mov_b32 v78, 0
    v_mov_b32 v79, 0
    v_mov_b32 v80, 0
    v_mov_b32 v81, 0
    v_mov_b32 v82, 0
    v_mov_b32 v83, 0
    v_mov_b32 v84, 0
    v_mov_b32 v85, 0
    v_mov_b32 v86, 0
    v_mov_b32 v87, 0
    v_mov_b32 v88, 0
    v_mov_b32 v89, 0
    v_mov_b32 v90, 0
    v_mov_b32 v91, 0
    v_mov_b32 v92, 0
    v_mov_b32 v93, 0
    v_mov_b32 v94, 0
    v_mov_b32 v95, 0
    buffer_load_dwordx4 v[220:223], v248, s[36:39], s60 offen
    buffer_load_dwordx4 v[224:227], v249, s[36:39], s60 offen
    buffer_load_dwordx4 v[228:231], v250, s[36:39], s60 offen
    buffer_load_dwordx4 v[232:235], v251, s[36:39], s60 offen
    buffer_load_dwordx4 v[236:239], v252, s[36:39], s60 offen
    buffer_load_dwordx4 v[204:207], v244, s[36:39], s60 offen
    buffer_load_dwordx4 v[208:211], v245, s[36:39], s60 offen
    buffer_load_dwordx4 v[212:215], v246, s[36:39], s60 offen
    buffer_load_dwordx4 v[216:219], v247, s[36:39], s60 offen
    s_add_u32 s60, s60, 1024
    s_cmp_eq_u32 s60, s61
    s_cselect_b32 s60, 0, s60
    s_waitcnt vmcnt(27)
    s_cmp_ge_u32 s26, 2
    s_cbranch_scc1 K2_M_SK1
    v_mfma_f32_16x16x32_bf16 v[16:19], v[112:115], v[96:99], v[16:19]
    v_mfma_f32_16x16x32_bf16 v[36:39], v[112:115], v[100:103], v[36:39]
    v_mfma_f32_16x16x32_bf16 v[56:59], v[112:115], v[104:107], v[56:59]
    v_mfma_f32_16x16x32_bf16 v[76:79], v[112:115], v[108:111], v[76:79]
    v_mfma_f32_16x16x32_bf16 v[20:23], v[116:119], v[96:99], v[20:23]
    v_mfma_f32_16x16x32_bf16 v[40:43], v[116:119], v[100:103], v[40:43]
    v_mfma_f32_16x16x32_bf16 v[60:63], v[116:119], v[104:107], v[60:63]
    v_mfma_f32_16x16x32_bf16 v[80:83], v[116:119], v[108:111], v[80:83]
    v_mfma_f32_16x16x32_bf16 v[24:27], v[120:123], v[96:99], v[24:27]
    v_mfma_f32_16x16x32_bf16 v[44:47], v[120:123], v[100:103], v[44:47]
    v_mfma_f32_16x16x32_bf16 v[64:67], v[120:123], v[104:107], v[64:67]
    v_mfma_f32_16x16x32_bf16 v[84:87], v[120:123], v[108:111], v[84:87]
    v_mfma_f32_16x16x32_bf16 v[28:31], v[124:127], v[96:99], v[28:31]
    v_mfma_f32_16x16x32_bf16 v[48:51], v[124:127], v[100:103], v[48:51]
    v_mfma_f32_16x16x32_bf16 v[68:71], v[124:127], v[104:107], v[68:71]
    v_mfma_f32_16x16x32_bf16 v[88:91], v[124:127], v[108:111], v[88:91]
    v_mfma_f32_16x16x32_bf16 v[32:35], v[128:131], v[96:99], v[32:35]
    v_mfma_f32_16x16x32_bf16 v[52:55], v[128:131], v[100:103], v[52:55]
    v_mfma_f32_16x16x32_bf16 v[72:75], v[128:131], v[104:107], v[72:75]
    v_mfma_f32_16x16x32_bf16 v[92:95], v[128:131], v[108:111], v[92:95]
K2_M_SK1:
    buffer_load_dwordx4 v[112:115], v248, s[36:39], s60 offen
    buffer_load_dwordx4 v[116:119], v249, s[36:39], s60 offen
    buffer_load_dwordx4 v[120:123], v250, s[36:39], s60 offen
    buffer_load_dwordx4 v[124:127], v251, s[36:39], s60 offen
    buffer_load_dwordx4 v[128:131], v252, s[36:39], s60 offen
    buffer_load_dwordx4 v[96:99], v244, s[36:39], s60 offen
    buffer_load_dwordx4 v[100:103], v245, s[36:39], s60 offen
    buffer_load_dwordx4 v[104:107], v246, s[36:39], s60 offen
    buffer_load_dwordx4 v[108:111], v247, s[36:39], s60 offen
    s_add_u32 s60, s60, 1024
    s_cmp_eq_u32 s60, s61
    s_cselect_b32 s60, 0, s60
    s_waitcnt vmcnt(27)
    v_mfma_f32_16x16x32_bf16 v[16:19], v[148:151], v[132:135], v[16:19]
    v_mfma_f32_16x16x32_bf16 v[36:39], v[148:151], v[136:139], v[36:39]
    v_mfma_f32_16x16x32_bf16 v[56:59], v[148:151], v[140:143], v[56:59]
    v_mfma_f32_16x16x32_bf16 v[76:79], v[148:151], v[144:147], v[76:79]
    v_mfma_f32_16x16x32_bf16 v[20:23], v[152:155], v[132:135], v[20:23]
    v_mfma_f32_16x16x32_bf16 v[40:43], v[152:155], v[136:139], v[40:43]
    v_mfma_f32_16x16x32_bf16 v[60:63], v[152:155], v[140:143], v[60:63]
    v_mfma_f32_16x16x32_bf16 v[80:83], v[152:155], v[144:147], v[80:83]
    v_mfma_f32_16x16x32_bf16 v[24:27], v[156:159], v[132:135], v[24:27]
    v_mfma_f32_16x16x32_bf16 v[44:47], v[156:159], v[136:139], v[44:47]
    v_mfma_f32_16x16x32_bf16 v[64:67], v[156:159], v[140:143], v[64:67]
    v_mfma_f32_16x16x32_bf16 v[84:87], v[156:159], v[144:147], v[84:87]
    v_mfma_f32_16x16x32_bf16 v[28:31], v[160:163], v[132:135], v[28:31]
    v_mfma_f32_16x16x32_bf16 v[48:51], v[160:163], v[136:139], v[48:51]
    v_mfma_f32_16x16x32_bf16 v[68:71], v[160:163], v[140:143], v[68:71]
    v_mfma_f32_16x16x32_bf16 v[88:91], v[160:163], v[144:147], v[88:91]
    v_mfma_f32_16x16x32_bf16 v[32:35], v[164:167], v[132:135], v[32:35]
    v_mfma_f32_16x16x32_bf16 v[52:55], v[164:167], v[136:139], v[52:55]
    v_mfma_f32_16x16x32_bf16 v[72:75], v[164:167], v[140:143], v[72:75]
    v_mfma_f32_16x16x32_bf16 v[92:95], v[164:167], v[144:147], v[92:95]
    buffer_load_dwordx4 v[148:151], v248, s[36:39], s60 offen
    buffer_load_dwordx4 v[152:155], v249, s[36:39], s60 offen
    buffer_load_dwordx4 v[156:159], v250, s[36:39], s60 offen
    buffer_load_dwordx4 v[160:163], v251, s[36:39], s60 offen
    buffer_load_dwordx4 v[164:167], v252, s[36:39], s60 offen
    buffer_load_dwordx4 v[132:135], v244, s[36:39], s60 offen
    buffer_load_dwordx4 v[136:139], v245, s[36:39], s60 offen
    buffer_load_dwordx4 v[140:143], v246, s[36:39], s60 offen
    buffer_load_dwordx4 v[144:147], v247, s[36:39], s60 offen
    s_add_u32 s60, s60, 1024
    s_cmp_eq_u32 s60, s61
    s_cselect_b32 s60, 0, s60
    s_waitcnt vmcnt(27)
    v_mfma_f32_16x16x32_bf16 v[16:19], v[184:187], v[168:171], v[16:19]
    v_mfma_f32_16x16x32_bf16 v[36:39], v[184:187], v[172:175], v[36:39]
    v_mfma_f32_16x16x32_bf16 v[56:59], v[184:187], v[176:179], v[56:59]
    v_mfma_f32_16x16x32_bf16 v[76:79], v[184:187], v[180:183], v[76:79]
    v_mfma_f32_16x16x32_bf16 v[20:23], v[188:191], v[168:171], v[20:23]
    v_mfma_f32_16x16x32_bf16 v[40:43], v[188:191], v[172:175], v[40:43]
    v_mfma_f32_16x16x32_bf16 v[60:63], v[188:191], v[176:179], v[60:63]
    v_mfma_f32_16x16x32_bf16 v[80:83], v[188:191], v[180:183], v[80:83]
    v_mfma_f32_16x16x32_bf16 v[24:27], v[192:195], v[168:171], v[24:27]
    v_mfma_f32_16x16x32_bf16 v[44:47], v[192:195], v[172:175], v[44:47]
    v_mfma_f32_16x16x32_bf16 v[64:67], v[192:195], v[176:179], v[64:67]
    v_mfma_f32_16x16x32_bf16 v[84:87], v[192:195], v[180:183], v[84:87]
    v_mfma_f32_16x16x32_bf16 v[28:31], v[196:199], v[168:171], v[28:31]
    v_mfma_f32_16x16x32_bf16 v[48:51], v[196:199], v[172:175], v[48:51]
    v_mfma_f32_16x16x32_bf16 v[68:71], v[196:199], v[176:179], v[68:71]
    v_mfma_f32_16x16x32_bf16 v[88:91], v[196:199], v[180:183], v[88:91]
    v_mfma_f32_16x16x32_bf16 v[32:35], v[200:203], v[168:171], v[32:35]
    v_mfma_f32_16x16x32_bf16 v[52:55], v[200:203], v[172:175], v[52:55]
    v_mfma_f32_16x16x32_bf16 v[72:75], v[200:203], v[176:179], v[72:75]
    v_mfma_f32_16x16x32_bf16 v[92:95], v[200:203], v[180:183], v[92:95]
    buffer_load_dwordx4 v[184:187], v248, s[36:39], s60 offen
    buffer_load_dwordx4 v[188:191], v249, s[36:39], s60 offen
    buffer_load_dwordx4 v[192:195], v250, s[36:39], s60 offen
    buffer_load_dwordx4 v[196:199], v251, s[36:39], s60 offen
    buffer_load_dwordx4 v[200:203], v252, s[36:39], s60 offen
    buffer_load_dwordx4 v[168:171], v244, s[36:39], s60 offen
    buffer_load_dwordx4 v[172:175], v245, s[36:39], s60 offen
    buffer_load_dwordx4 v[176:179], v246, s[36:39], s60 offen
    buffer_load_dwordx4 v[180:183], v247, s[36:39], s60 offen
    s_add_u32 s60, s60, 1024
    s_cmp_eq_u32 s60, s61
    s_cselect_b32 s60, 0, s60
    s_waitcnt vmcnt(27)
    v_mfma_f32_16x16x32_bf16 v[16:19], v[220:223], v[204:207], v[16:19]
    v_mfma_f32_16x16x32_bf16 v[36:39], v[220:223], v[208:211], v[36:39]
    v_mfma_f32_16x16x32_bf16 v[56:59], v[220:223], v[212:215], v[56:59]
    v_mfma_f32_16x16x32_bf16 v[76:79], v[220:223], v[216:219], v[76:79]
    v_mfma_f32_16x16x32_bf16 v[20:23], v[224:227], v[204:207], v[20:23]
    v_mfma_f32_16x16x32_bf16 v[40:43], v[224:227], v[208:211], v[40:43]
    v_mfma_f32_16x16x32_bf16 v[60:63], v[224:227], v[212:215], v[60:63]
    v_mfma_f32_16x16x32_bf16 v[80:83], v[224:227], v[216:219], v[80:83]
    v_mfma_f32_16x16x32_bf16 v[24:27], v[228:231], v[204:207], v[24:27]
    v_mfma_f32_16x16x32_bf16 v[44:47], v[228:231], v[208:211], v[44:47]
    v_mfma_f32_16x16x32_bf16 v[64:67], v[228:231], v[212:215], v[64:67]
    v_mfma_f32_16x16x32_bf16 v[84:87], v[228:231], v[216:219], v[84:87]
    v_mfma_f32_16x16x32_bf16 v[28:31], v[232:235], v[204:207], v[28:31]
    v_mfma_f32_16x16x32_bf16 v[48:51], v[232:235], v[208:211], v[48:51]
    v_mfma_f32_16x16x32_bf16 v[68:71], v[232:235], v[212:215], v[68:71]
    v_mfma_f32_16x16x32_bf16 v[88:91], v[232:235], v[216:219], v[88:91]
    v_mfma_f32_16x16x32_bf16 v[32:35], v[236:239], v[204:207], v[32:35]
    v_mfma_f32_16x16x32_bf16 v[52:55], v[236:239], v[208:211], v[52:55]
    v_mfma_f32_16x16x32_bf16 v[72:75], v[236:239], v[212:215], v[72:75]
    v_mfma_f32_16x16x32_bf16 v[92:95], v[236:239], v[216:219], v[92:95]
    buffer_load_dwordx4 v[220:223], v248, s[36:39], s60 offen
    buffer_load_dwordx4 v[224:227], v249, s[36:39], s60 offen
    buffer_load_dwordx4 v[228:231], v250, s[36:39], s60 offen
    buffer_load_dwordx4 v[232:235], v251, s[36:39], s60 offen
    buffer_load_dwordx4 v[236:239], v252, s[36:39], s60 offen
    buffer_load_dwordx4 v[204:207], v244, s[36:39], s60 offen
    buffer_load_dwordx4 v[208:211], v245, s[36:39], s60 offen
    buffer_load_dwordx4 v[212:215], v246, s[36:39], s60 offen
    buffer_load_dwordx4 v[216:219], v247, s[36:39], s60 offen
    s_add_u32 s60, s60, 1024
    s_cmp_eq_u32 s60, s61
    s_cselect_b32 s60, 0, s60
    s_waitcnt vmcnt(27)
    v_mfma_f32_16x16x32_bf16 v[16:19], v[112:115], v[96:99], v[16:19]
    v_mfma_f32_16x16x32_bf16 v[36:39], v[112:115], v[100:103], v[36:39]
    v_mfma_f32_16x16x32_bf16 v[56:59], v[112:115], v[104:107], v[56:59]
    v_mfma_f32_16x16x32_bf16 v[76:79], v[112:115], v[108:111], v[76:79]
    v_mfma_f32_16x16x32_bf16 v[20:23], v[116:119], v[96:99], v[20:23]
    v_mfma_f32_16x16x32_bf16 v[40:43], v[116:119], v[100:103], v[40:43]
    v_mfma_f32_16x16x32_bf16 v[60:63], v[116:119], v[104:107], v[60:63]
    v_mfma_f32_16x16x32_bf16 v[80:83], v[116:119], v[108:111], v[80:83]
    v_mfma_f32_16x16x32_bf16 v[24:27], v[120:123], v[96:99], v[24:27]
    v_mfma_f32_16x16x32_bf16 v[44:47], v[120:123], v[100:103], v[44:47]
    v_mfma_f32_16x16x32_bf16 v[64:67], v[120:123], v[104:107], v[64:67]
    v_mfma_f32_16x16x32_bf16 v[84:87], v[120:123], v[108:111], v[84:87]
    v_mfma_f32_16x16x32_bf16 v[28:31], v[124:127], v[96:99], v[28:31]
    v_mfma_f32_16x16x32_bf16 v[48:51], v[124:127], v[100:103], v[48:51]
    v_mfma_f32_16x16x32_bf16 v[68:71], v[124:127], v[104:107], v[68:71]
    v_mfma_f32_16x16x32_bf16 v[88:91], v[124:127], v[108:111], v[88:91]
    v_mfma_f32_16x16x32_bf16 v[32:35], v[128:131], v[96:99], v[32:35]
    v_mfma_f32_16x16x32_bf16 v[52:55], v[128:131], v[100:103], v[52:55]
    v_mfma_f32_16x16x32_bf16 v[72:75], v[128:131], v[104:107], v[72:75]
    v_mfma_f32_16x16x32_bf16 v[92:95], v[128:131], v[108:111], v[92:95]
    buffer_load_dwordx4 v[112:115], v248, s[36:39], s60 offen
    buffer_load_dwordx4 v[116:119], v249, s[36:39], s60 offen
    buffer_load_dwordx4 v[120:123], v250, s[36:39], s60 offen
    buffer_load_dwordx4 v[124:127], v251, s[36:39], s60 offen
    buffer_load_dwordx4 v[128:131], v252, s[36:39], s60 offen
    buffer_load_dwordx4 v[96:99], v244, s[36:39], s60 offen
    buffer_load_dwordx4 v[100:103], v245, s[36:39], s60 offen
    buffer_load_dwordx4 v[104:107], v246, s[36:39], s60 offen
    buffer_load_dwordx4 v[108:111], v247, s[36:39], s60 offen
    s_add_u32 s60, s60, 1024
    s_cmp_eq_u32 s60, s61
    s_cselect_b32 s60, 0, s60
    s_waitcnt vmcnt(27)
    v_mfma_f32_16x16x32_bf16 v[16:19], v[148:151], v[132:135], v[16:19]
    v_mfma_f32_16x16x32_bf16 v[36:39], v[148:151], v[136:139], v[36:39]
    v_mfma_f32_16x16x32_bf16 v[56:59], v[148:151], v[140:143], v[56:59]
    v_mfma_f32_16x16x32_bf16 v[76:79], v[148:151], v[144:147], v[76:79]
    v_mfma_f32_16x16x32_bf16 v[20:23], v[152:155], v[132:135], v[20:23]
    v_mfma_f32_16x16x32_bf16 v[40:43], v[152:155], v[136:139], v[40:43]
    v_mfma_f32_16x16x32_bf16 v[60:63], v[152:155], v[140:143], v[60:63]
    v_mfma_f32_16x16x32_bf16 v[80:83], v[152:155], v[144:147], v[80:83]
    v_mfma_f32_16x16x32_bf16 v[24:27], v[156:159], v[132:135], v[24:27]
    v_mfma_f32_16x16x32_bf16 v[44:47], v[156:159], v[136:139], v[44:47]
    v_mfma_f32_16x16x32_bf16 v[64:67], v[156:159], v[140:143], v[64:67]
    v_mfma_f32_16x16x32_bf16 v[84:87], v[156:159], v[144:147], v[84:87]
    v_mfma_f32_16x16x32_bf16 v[28:31], v[160:163], v[132:135], v[28:31]
    v_mfma_f32_16x16x32_bf16 v[48:51], v[160:163], v[136:139], v[48:51]
    v_mfma_f32_16x16x32_bf16 v[68:71], v[160:163], v[140:143], v[68:71]
    v_mfma_f32_16x16x32_bf16 v[88:91], v[160:163], v[144:147], v[88:91]
    v_mfma_f32_16x16x32_bf16 v[32:35], v[164:167], v[132:135], v[32:35]
    v_mfma_f32_16x16x32_bf16 v[52:55], v[164:167], v[136:139], v[52:55]
    v_mfma_f32_16x16x32_bf16 v[72:75], v[164:167], v[140:143], v[72:75]
    v_mfma_f32_16x16x32_bf16 v[92:95], v[164:167], v[144:147], v[92:95]
    buffer_load_dwordx4 v[148:151], v248, s[36:39], s60 offen
    buffer_load_dwordx4 v[152:155], v249, s[36:39], s60 offen
    buffer_load_dwordx4 v[156:159], v250, s[36:39], s60 offen
    buffer_load_dwordx4 v[160:163], v251, s[36:39], s60 offen
    buffer_load_dwordx4 v[164:167], v252, s[36:39], s60 offen
    buffer_load_dwordx4 v[132:135], v244, s[36:39], s60 offen
    buffer_load_dwordx4 v[136:139], v245, s[36:39], s60 offen
    buffer_load_dwordx4 v[140:143], v246, s[36:39], s60 offen
    buffer_load_dwordx4 v[144:147], v247, s[36:39], s60 offen
    s_add_u32 s60, s60, 1024
    s_cmp_eq_u32 s60, s61
    s_cselect_b32 s60, 0, s60
    s_waitcnt vmcnt(27)
    v_mfma_f32_16x16x32_bf16 v[16:19], v[184:187], v[168:171], v[16:19]
    v_mfma_f32_16x16x32_bf16 v[36:39], v[184:187], v[172:175], v[36:39]
    v_mfma_f32_16x16x32_bf16 v[56:59], v[184:187], v[176:179], v[56:59]
    v_mfma_f32_16x16x32_bf16 v[76:79], v[184:187], v[180:183], v[76:79]
    v_mfma_f32_16x16x32_bf16 v[20:23], v[188:191], v[168:171], v[20:23]
    v_mfma_f32_16x16x32_bf16 v[40:43], v[188:191], v[172:175], v[40:43]
    v_mfma_f32_16x16x32_bf16 v[60:63], v[188:191], v[176:179], v[60:63]
    v_mfma_f32_16x16x32_bf16 v[80:83], v[188:191], v[180:183], v[80:83]
    v_mfma_f32_16x16x32_bf16 v[24:27], v[192:195], v[168:171], v[24:27]
    v_mfma_f32_16x16x32_bf16 v[44:47], v[192:195], v[172:175], v[44:47]
    v_mfma_f32_16x16x32_bf16 v[64:67], v[192:195], v[176:179], v[64:67]
    v_mfma_f32_16x16x32_bf16 v[84:87], v[192:195], v[180:183], v[84:87]
    v_mfma_f32_16x16x32_bf16 v[28:31], v[196:199], v[168:171], v[28:31]
    v_mfma_f32_16x16x32_bf16 v[48:51], v[196:199], v[172:175], v[48:51]
    v_mfma_f32_16x16x32_bf16 v[68:71], v[196:199], v[176:179], v[68:71]
    v_mfma_f32_16x16x32_bf16 v[88:91], v[196:199], v[180:183], v[88:91]
    v_mfma_f32_16x16x32_bf16 v[32:35], v[200:203], v[168:171], v[32:35]
    v_mfma_f32_16x16x32_bf16 v[52:55], v[200:203], v[172:175], v[52:55]
    v_mfma_f32_16x16x32_bf16 v[72:75], v[200:203], v[176:179], v[72:75]
    v_mfma_f32_16x16x32_bf16 v[92:95], v[200:203], v[180:183], v[92:95]
    buffer_load_dwordx4 v[184:187], v248, s[36:39], s60 offen
    buffer_load_dwordx4 v[188:191], v249, s[36:39], s60 offen
    buffer_load_dwordx4 v[192:195], v250, s[36:39], s60 offen
    buffer_load_dwordx4 v[196:199], v251, s[36:39], s60 offen
    buffer_load_dwordx4 v[200:203], v252, s[36:39], s60 offen
    buffer_load_dwordx4 v[168:171], v244, s[36:39], s60 offen
    buffer_load_dwordx4 v[172:175], v245, s[36:39], s60 offen
    buffer_load_dwordx4 v[176:179], v246, s[36:39], s60 offen
    buffer_load_dwordx4 v[180:183], v247, s[36:39], s60 offen
    s_add_u32 s60, s60, 1024
    s_cmp_eq_u32 s60, s61
    s_cselect_b32 s60, 0, s60
    s_waitcnt vmcnt(27)
    v_mfma_f32_16x16x32_bf16 v[16:19], v[220:223], v[204:207], v[16:19]
    v_mfma_f32_16x16x32_bf16 v[36:39], v[220:223], v[208:211], v[36:39]
    v_mfma_f32_16x16x32_bf16 v[56:59], v[220:223], v[212:215], v[56:59]
    v_mfma_f32_16x16x32_bf16 v[76:79], v[220:223], v[216:219], v[76:79]
    v_mfma_f32_16x16x32_bf16 v[20:23], v[224:227], v[204:207], v[20:23]
    v_mfma_f32_16x16x32_bf16 v[40:43], v[224:227], v[208:211], v[40:43]
    v_mfma_f32_16x16x32_bf16 v[60:63], v[224:227], v[212:215], v[60:63]
    v_mfma_f32_16x16x32_bf16 v[80:83], v[224:227], v[216:219], v[80:83]
    v_mfma_f32_16x16x32_bf16 v[24:27], v[228:231], v[204:207], v[24:27]
    v_mfma_f32_16x16x32_bf16 v[44:47], v[228:231], v[208:211], v[44:47]
    v_mfma_f32_16x16x32_bf16 v[64:67], v[228:231], v[212:215], v[64:67]
    v_mfma_f32_16x16x32_bf16 v[84:87], v[228:231], v[216:219], v[84:87]
    v_mfma_f32_16x16x32_bf16 v[28:31], v[232:235], v[204:207], v[28:31]
    v_mfma_f32_16x16x32_bf16 v[48:51], v[232:235], v[208:211], v[48:51]
    v_mfma_f32_16x16x32_bf16 v[68:71], v[232:235], v[212:215], v[68:71]
    v_mfma_f32_16x16x32_bf16 v[88:91], v[232:235], v[216:219], v[88:91]
    v_mfma_f32_16x16x32_bf16 v[32:35], v[236:239], v[204:207], v[32:35]
    v_mfma_f32_16x16x32_bf16 v[52:55], v[236:239], v[208:211], v[52:55]
    v_mfma_f32_16x16x32_bf16 v[72:75], v[236:239], v[212:215], v[72:75]
    v_mfma_f32_16x16x32_bf16 v[92:95], v[236:239], v[216:219], v[92:95]
    buffer_load_dwordx4 v[220:223], v248, s[36:39], s60 offen
    buffer_load_dwordx4 v[224:227], v249, s[36:39], s60 offen
    buffer_load_dwordx4 v[228:231], v250, s[36:39], s60 offen
    buffer_load_dwordx4 v[232:235], v251, s[36:39], s60 offen
    buffer_load_dwordx4 v[236:239], v252, s[36:39], s60 offen
    buffer_load_dwordx4 v[204:207], v244, s[36:39], s60 offen
    buffer_load_dwordx4 v[208:211], v245, s[36:39], s60 offen
    buffer_load_dwordx4 v[212:215], v246, s[36:39], s60 offen
    buffer_load_dwordx4 v[216:219], v247, s[36:39], s60 offen
    s_add_u32 s60, s60, 1024
    s_cmp_eq_u32 s60, s61
    s_cselect_b32 s60, 0, s60
    s_waitcnt vmcnt(27)
    v_mfma_f32_16x16x32_bf16 v[16:19], v[112:115], v[96:99], v[16:19]
    v_mfma_f32_16x16x32_bf16 v[36:39], v[112:115], v[100:103], v[36:39]
    v_mfma_f32_16x16x32_bf16 v[56:59], v[112:115], v[104:107], v[56:59]
    v_mfma_f32_16x16x32_bf16 v[76:79], v[112:115], v[108:111], v[76:79]
    v_mfma_f32_16x16x32_bf16 v[20:23], v[116:119], v[96:99], v[20:23]
    v_mfma_f32_16x16x32_bf16 v[40:43], v[116:119], v[100:103], v[40:43]
    v_mfma_f32_16x16x32_bf16 v[60:63], v[116:119], v[104:107], v[60:63]
    v_mfma_f32_16x16x32_bf16 v[80:83], v[116:119], v[108:111], v[80:83]
    v_mfma_f32_16x16x32_bf16 v[24:27], v[120:123], v[96:99], v[24:27]
    v_mfma_f32_16x16x32_bf16 v[44:47], v[120:123], v[100:103], v[44:47]
    v_mfma_f32_16x16x32_bf16 v[64:67], v[120:123], v[104:107], v[64:67]
    v_mfma_f32_16x16x32_bf16 v[84:87], v[120:123], v[108:111], v[84:87]
    v_mfma_f32_16x16x32_bf16 v[28:31], v[124:127], v[96:99], v[28:31]
    v_mfma_f32_16x16x32_bf16 v[48:51], v[124:127], v[100:103], v[48:51]
    v_mfma_f32_16x16x32_bf16 v[68:71], v[124:127], v[104:107], v[68:71]
    v_mfma_f32_16x16x32_bf16 v[88:91], v[124:127], v[108:111], v[88:91]
    v_mfma_f32_16x16x32_bf16 v[32:35], v[128:131], v[96:99], v[32:35]
    v_mfma_f32_16x16x32_bf16 v[52:55], v[128:131], v[100:103], v[52:55]
    v_mfma_f32_16x16x32_bf16 v[72:75], v[128:131], v[104:107], v[72:75]
    v_mfma_f32_16x16x32_bf16 v[92:95], v[128:131], v[108:111], v[92:95]
    buffer_load_dwordx4 v[112:115], v248, s[36:39], s60 offen
    buffer_load_dwordx4 v[116:119], v249, s[36:39], s60 offen
    buffer_load_dwordx4 v[120:123], v250, s[36:39], s60 offen
    buffer_load_dwordx4 v[124:127], v251, s[36:39], s60 offen
    buffer_load_dwordx4 v[128:131], v252, s[36:39], s60 offen
    buffer_load_dwordx4 v[96:99], v244, s[36:39], s60 offen
    buffer_load_dwordx4 v[100:103], v245, s[36:39], s60 offen
    buffer_load_dwordx4 v[104:107], v246, s[36:39], s60 offen
    buffer_load_dwordx4 v[108:111], v247, s[36:39], s60 offen
    s_add_u32 s60, s60, 1024
    s_cmp_eq_u32 s60, s61
    s_cselect_b32 s60, 0, s60
    s_waitcnt vmcnt(27)
    v_mfma_f32_16x16x32_bf16 v[16:19], v[148:151], v[132:135], v[16:19]
    v_mfma_f32_16x16x32_bf16 v[36:39], v[148:151], v[136:139], v[36:39]
    v_mfma_f32_16x16x32_bf16 v[56:59], v[148:151], v[140:143], v[56:59]
    v_mfma_f32_16x16x32_bf16 v[76:79], v[148:151], v[144:147], v[76:79]
    v_mfma_f32_16x16x32_bf16 v[20:23], v[152:155], v[132:135], v[20:23]
    v_mfma_f32_16x16x32_bf16 v[40:43], v[152:155], v[136:139], v[40:43]
    v_mfma_f32_16x16x32_bf16 v[60:63], v[152:155], v[140:143], v[60:63]
    v_mfma_f32_16x16x32_bf16 v[80:83], v[152:155], v[144:147], v[80:83]
    v_mfma_f32_16x16x32_bf16 v[24:27], v[156:159], v[132:135], v[24:27]
    v_mfma_f32_16x16x32_bf16 v[44:47], v[156:159], v[136:139], v[44:47]
    v_mfma_f32_16x16x32_bf16 v[64:67], v[156:159], v[140:143], v[64:67]
    v_mfma_f32_16x16x32_bf16 v[84:87], v[156:159], v[144:147], v[84:87]
    v_mfma_f32_16x16x32_bf16 v[28:31], v[160:163], v[132:135], v[28:31]
    v_mfma_f32_16x16x32_bf16 v[48:51], v[160:163], v[136:139], v[48:51]
    v_mfma_f32_16x16x32_bf16 v[68:71], v[160:163], v[140:143], v[68:71]
    v_mfma_f32_16x16x32_bf16 v[88:91], v[160:163], v[144:147], v[88:91]
    v_mfma_f32_16x16x32_bf16 v[32:35], v[164:167], v[132:135], v[32:35]
    v_mfma_f32_16x16x32_bf16 v[52:55], v[164:167], v[136:139], v[52:55]
    v_mfma_f32_16x16x32_bf16 v[72:75], v[164:167], v[140:143], v[72:75]
    v_mfma_f32_16x16x32_bf16 v[92:95], v[164:167], v[144:147], v[92:95]
    buffer_load_dwordx4 v[148:151], v248, s[36:39], s60 offen
    buffer_load_dwordx4 v[152:155], v249, s[36:39], s60 offen
    buffer_load_dwordx4 v[156:159], v250, s[36:39], s60 offen
    buffer_load_dwordx4 v[160:163], v251, s[36:39], s60 offen
    buffer_load_dwordx4 v[164:167], v252, s[36:39], s60 offen
    buffer_load_dwordx4 v[132:135], v244, s[36:39], s60 offen
    buffer_load_dwordx4 v[136:139], v245, s[36:39], s60 offen
    buffer_load_dwordx4 v[140:143], v246, s[36:39], s60 offen
    buffer_load_dwordx4 v[144:147], v247, s[36:39], s60 offen
    s_add_u32 s60, s60, 1024
    s_cmp_eq_u32 s60, s61
    s_cselect_b32 s60, 0, s60
    s_waitcnt vmcnt(27)
    v_mfma_f32_16x16x32_bf16 v[16:19], v[184:187], v[168:171], v[16:19]
    v_mfma_f32_16x16x32_bf16 v[36:39], v[184:187], v[172:175], v[36:39]
    v_mfma_f32_16x16x32_bf16 v[56:59], v[184:187], v[176:179], v[56:59]
    v_mfma_f32_16x16x32_bf16 v[76:79], v[184:187], v[180:183], v[76:79]
    v_mfma_f32_16x16x32_bf16 v[20:23], v[188:191], v[168:171], v[20:23]
    v_mfma_f32_16x16x32_bf16 v[40:43], v[188:191], v[172:175], v[40:43]
    v_mfma_f32_16x16x32_bf16 v[60:63], v[188:191], v[176:179], v[60:63]
    v_mfma_f32_16x16x32_bf16 v[80:83], v[188:191], v[180:183], v[80:83]
    v_mfma_f32_16x16x32_bf16 v[24:27], v[192:195], v[168:171], v[24:27]
    v_mfma_f32_16x16x32_bf16 v[44:47], v[192:195], v[172:175], v[44:47]
    v_mfma_f32_16x16x32_bf16 v[64:67], v[192:195], v[176:179], v[64:67]
    v_mfma_f32_16x16x32_bf16 v[84:87], v[192:195], v[180:183], v[84:87]
    v_mfma_f32_16x16x32_bf16 v[28:31], v[196:199], v[168:171], v[28:31]
    v_mfma_f32_16x16x32_bf16 v[48:51], v[196:199], v[172:175], v[48:51]
    v_mfma_f32_16x16x32_bf16 v[68:71], v[196:199], v[176:179], v[68:71]
    v_mfma_f32_16x16x32_bf16 v[88:91], v[196:199], v[180:183], v[88:91]
    v_mfma_f32_16x16x32_bf16 v[32:35], v[200:203], v[168:171], v[32:35]
    v_mfma_f32_16x16x32_bf16 v[52:55], v[200:203], v[172:175], v[52:55]
    v_mfma_f32_16x16x32_bf16 v[72:75], v[200:203], v[176:179], v[72:75]
    v_mfma_f32_16x16x32_bf16 v[92:95], v[200:203], v[180:183], v[92:95]
    s_waitcnt vmcnt(18)
    v_mfma_f32_16x16x32_bf16 v[16:19], v[220:223], v[204:207], v[16:19]
    v_mfma_f32_16x16x32_bf16 v[36:39], v[220:223], v[208:211], v[36:39]
    v_mfma_f32_16x16x32_bf16 v[56:59], v[220:223], v[212:215], v[56:59]
    v_mfma_f32_16x16x32_bf16 v[76:79], v[220:223], v[216:219], v[76:79]
    v_mfma_f32_16x16x32_bf16 v[20:23], v[224:227], v[204:207], v[20:23]
    v_mfma_f32_16x16x32_bf16 v[40:43], v[224:227], v[208:211], v[40:43]
    v_mfma_f32_16x16x32_bf16 v[60:63], v[224:227], v[212:215], v[60:63]
    v_mfma_f32_16x16x32_bf16 v[80:83], v[224:227], v[216:219], v[80:83]
    v_mfma_f32_16x16x32_bf16 v[24:27], v[228:231], v[204:207], v[24:27]
    v_mfma_f32_16x16x32_bf16 v[44:47], v[228:231], v[208:211], v[44:47]
    v_mfma_f32_16x16x32_bf16 v[64:67], v[228:231], v[212:215], v[64:67]
    v_mfma_f32_16x16x32_bf16 v[84:87], v[228:231], v[216:219], v[84:87]
    v_mfma_f32_16x16x32_bf16 v[28:31], v[232:235], v[204:207], v[28:31]
    v_mfma_f32_16x16x32_bf16 v[48:51], v[232:235], v[208:211], v[48:51]
    v_mfma_f32_16x16x32_bf16 v[68:71], v[232:235], v[212:215], v[68:71]
    v_mfma_f32_16x16x32_bf16 v[88:91], v[232:235], v[216:219], v[88:91]
    v_mfma_f32_16x16x32_bf16 v[32:35], v[236:239], v[204:207], v[32:35]
    v_mfma_f32_16x16x32_bf16 v[52:55], v[236:239], v[208:211], v[52:55]
    v_mfma_f32_16x16x32_bf16 v[72:75], v[236:239], v[212:215], v[72:75]
    v_mfma_f32_16x16x32_bf16 v[92:95], v[236:239], v[216:219], v[92:95]
    s_waitcnt vmcnt(9)
    v_mfma_f32_16x16x32_bf16 v[16:19], v[112:115], v[96:99], v[16:19]
    v_mfma_f32_16x16x32_bf16 v[36:39], v[112:115], v[100:103], v[36:39]
    v_mfma_f32_16x16x32_bf16 v[56:59], v[112:115], v[104:107], v[56:59]
    v_mfma_f32_16x16x32_bf16 v[76:79], v[112:115], v[108:111], v[76:79]
    v_mfma_f32_16x16x32_bf16 v[20:23], v[116:119], v[96:99], v[20:23]
    v_mfma_f32_16x16x32_bf16 v[40:43], v[116:119], v[100:103], v[40:43]
    v_mfma_f32_16x16x32_bf16 v[60:63], v[116:119], v[104:107], v[60:63]
    v_mfma_f32_16x16x32_bf16 v[80:83], v[116:119], v[108:111], v[80:83]
    v_mfma_f32_16x16x32_bf16 v[24:27], v[120:123], v[96:99], v[24:27]
    v_mfma_f32_16x16x32_bf16 v[44:47], v[120:123], v[100:103], v[44:47]
    v_mfma_f32_16x16x32_bf16 v[64:67], v[120:123], v[104:107], v[64:67]
    v_mfma_f32_16x16x32_bf16 v[84:87], v[120:123], v[108:111], v[84:87]
    v_mfma_f32_16x16x32_bf16 v[28:31], v[124:127], v[96:99], v[28:31]
    v_mfma_f32_16x16x32_bf16 v[48:51], v[124:127], v[100:103], v[48:51]
    v_mfma_f32_16x16x32_bf16 v[68:71], v[124:127], v[104:107], v[68:71]
    v_mfma_f32_16x16x32_bf16 v[88:91], v[124:127], v[108:111], v[88:91]
    v_mfma_f32_16x16x32_bf16 v[32:35], v[128:131], v[96:99], v[32:35]
    v_mfma_f32_16x16x32_bf16 v[52:55], v[128:131], v[100:103], v[52:55]
    v_mfma_f32_16x16x32_bf16 v[72:75], v[128:131], v[104:107], v[72:75]
    v_mfma_f32_16x16x32_bf16 v[92:95], v[128:131], v[108:111], v[92:95]
    s_waitcnt vmcnt(0)
    v_mfma_f32_16x16x32_bf16 v[16:19], v[148:151], v[132:135], v[16:19]
    v_mfma_f32_16x16x32_bf16 v[36:39], v[148:151], v[136:139], v[36:39]
    v_mfma_f32_16x16x32_bf16 v[56:59], v[148:151], v[140:143], v[56:59]
    v_mfma_f32_16x16x32_bf16 v[76:79], v[148:151], v[144:147], v[76:79]
    v_mfma_f32_16x16x32_bf16 v[20:23], v[152:155], v[132:135], v[20:23]
    v_mfma_f32_16x16x32_bf16 v[40:43], v[152:155], v[136:139], v[40:43]
    v_mfma_f32_16x16x32_bf16 v[60:63], v[152:155], v[140:143], v[60:63]
    v_mfma_f32_16x16x32_bf16 v[80:83], v[152:155], v[144:147], v[80:83]
    v_mfma_f32_16x16x32_bf16 v[24:27], v[156:159], v[132:135], v[24:27]
    v_mfma_f32_16x16x32_bf16 v[44:47], v[156:159], v[136:139], v[44:47]
    v_mfma_f32_16x16x32_bf16 v[64:67], v[156:159], v[140:143], v[64:67]
    v_mfma_f32_16x16x32_bf16 v[84:87], v[156:159], v[144:147], v[84:87]
    v_mfma_f32_16x16x32_bf16 v[28:31], v[160:163], v[132:135], v[28:31]
    v_mfma_f32_16x16x32_bf16 v[48:51], v[160:163], v[136:139], v[48:51]
    v_mfma_f32_16x16x32_bf16 v[68:71], v[160:163], v[140:143], v[68:71]
    v_mfma_f32_16x16x32_bf16 v[88:91], v[160:163], v[144:147], v[88:91]
    v_mfma_f32_16x16x32_bf16 v[32:35], v[164:167], v[132:135], v[32:35]
    v_mfma_f32_16x16x32_bf16 v[52:55], v[164:167], v[136:139], v[52:55]
    v_mfma_f32_16x16x32_bf16 v[72:75], v[164:167], v[140:143], v[72:75]
    v_mfma_f32_16x16x32_bf16 v[92:95], v[164:167], v[144:147], v[92:95]
K2_M_DONE:
    v_sub_f32 v244, 1.0, v240
    v_sub_f32 v245, 1.0, v240
    v_sub_f32 v246, 1.0, v241
    v_sub_f32 v247, 1.0, v241
    v_sub_f32 v248, 1.0, v242
    v_sub_f32 v249, 1.0, v242
    v_sub_f32 v250, 1.0, v243
    v_sub_f32 v251, 1.0, v243
    v_add_u32 v7, 81920, v2
    v_add_u32 v10, 116736, v2
    s_nop 4
    v_pk_mul_f32 v[16:17], v[16:17], v[244:245]
    v_pk_mul_f32 v[18:19], v[18:19], v[244:245]
    v_pk_mul_f32 v[20:21], v[20:21], v[244:245]
    v_pk_mul_f32 v[22:23], v[22:23], v[244:245]
    v_pk_mul_f32 v[24:25], v[24:25], v[244:245]
    v_pk_mul_f32 v[26:27], v[26:27], v[244:245]
    v_pk_mul_f32 v[28:29], v[28:29], v[244:245]
    v_pk_mul_f32 v[30:31], v[30:31], v[244:245]
    v_pk_mul_f32 v[32:33], v[32:33], v[244:245]
    v_pk_mul_f32 v[34:35], v[34:35], v[244:245]
    v_pk_mul_f32 v[36:37], v[36:37], v[246:247]
    v_pk_mul_f32 v[38:39], v[38:39], v[246:247]
    v_pk_mul_f32 v[40:41], v[40:41], v[246:247]
    v_pk_mul_f32 v[42:43], v[42:43], v[246:247]
    v_pk_mul_f32 v[44:45], v[44:45], v[246:247]
    v_pk_mul_f32 v[46:47], v[46:47], v[246:247]
    v_pk_mul_f32 v[48:49], v[48:49], v[246:247]
    v_pk_mul_f32 v[50:51], v[50:51], v[246:247]
    v_pk_mul_f32 v[52:53], v[52:53], v[246:247]
    v_pk_mul_f32 v[54:55], v[54:55], v[246:247]
    v_pk_mul_f32 v[56:57], v[56:57], v[248:249]
    v_pk_mul_f32 v[58:59], v[58:59], v[248:249]
    v_pk_mul_f32 v[60:61], v[60:61], v[248:249]
    v_pk_mul_f32 v[62:63], v[62:63], v[248:249]
    v_pk_mul_f32 v[64:65], v[64:65], v[248:249]
    v_pk_mul_f32 v[66:67], v[66:67], v[248:249]
    v_pk_mul_f32 v[68:69], v[68:69], v[248:249]
    v_pk_mul_f32 v[70:71], v[70:71], v[248:249]
    v_pk_mul_f32 v[72:73], v[72:73], v[248:249]
    v_pk_mul_f32 v[74:75], v[74:75], v[248:249]
    v_pk_mul_f32 v[76:77], v[76:77], v[250:251]
    v_pk_mul_f32 v[78:79], v[78:79], v[250:251]
    v_pk_mul_f32 v[80:81], v[80:81], v[250:251]
    v_pk_mul_f32 v[82:83], v[82:83], v[250:251]
    v_pk_mul_f32 v[84:85], v[84:85], v[250:251]
    v_pk_mul_f32 v[86:87], v[86:87], v[250:251]
    v_pk_mul_f32 v[88:89], v[88:89], v[250:251]
    v_pk_mul_f32 v[90:91], v[90:91], v[250:251]
    v_pk_mul_f32 v[92:93], v[92:93], v[250:251]
    v_pk_mul_f32 v[94:95], v[94:95], v[250:251]
    s_cmp_eq_u32 s26, 0
    s_cbranch_scc0 K2_X0
    ds_write_b128 v7, v[28:31] offset:15360
    ds_write_b128 v7, v[32:35] offset:16384
    ds_write_b128 v7, v[36:39] offset:17408
    ds_write_b128 v7, v[40:43] offset:18432
    ds_write_b128 v7, v[44:47] offset:19456
    ds_write_b128 v7, v[48:51] offset:20480
    ds_write_b128 v7, v[52:55] offset:21504
    ds_write_b128 v10, v[56:59] offset:0
    ds_write_b128 v10, v[60:63] offset:1024
    ds_write_b128 v10, v[64:67] offset:2048
    ds_write_b128 v10, v[68:71] offset:3072
    ds_write_b128 v10, v[72:75] offset:4096
    ds_write_b128 v10, v[76:79] offset:17408
    ds_write_b128 v10, v[80:83] offset:18432
    ds_write_b128 v10, v[84:87] offset:19456
    ds_write_b128 v10, v[88:91] offset:20480
    ds_write_b128 v10, v[92:95] offset:21504
    v_mov_b32 v192, v16
    v_mov_b32 v193, v17
    v_mov_b32 v194, v18
    v_mov_b32 v195, v19
    v_mov_b32 v196, v20
    v_mov_b32 v197, v21
    v_mov_b32 v198, v22
    v_mov_b32 v199, v23
    v_mov_b32 v200, v24
    v_mov_b32 v201, v25
    v_mov_b32 v202, v26
    v_mov_b32 v203, v27
    s_branch K2_XD
K2_X0:
    s_cmp_eq_u32 s26, 1
    s_cbranch_scc0 K2_X1
    ds_write_b128 v7, v[16:19] offset:0
    ds_write_b128 v7, v[20:23] offset:1024
    ds_write_b128 v7, v[24:27] offset:2048
    ds_write_b128 v7, v[28:31] offset:3072
    ds_write_b128 v7, v[32:35] offset:4096
    ds_write_b128 v7, v[48:51] offset:32768
    ds_write_b128 v7, v[52:55] offset:33792
    ds_write_b128 v10, v[56:59] offset:5120
    ds_write_b128 v10, v[60:63] offset:6144
    ds_write_b128 v10, v[64:67] offset:7168
    ds_write_b128 v10, v[68:71] offset:8192
    ds_write_b128 v10, v[72:75] offset:9216
    ds_write_b128 v10, v[76:79] offset:22528
    ds_write_b128 v10, v[80:83] offset:23552
    ds_write_b128 v10, v[84:87] offset:24576
    ds_write_b128 v10, v[88:91] offset:25600
    ds_write_b128 v10, v[92:95] offset:26624
    v_mov_b32 v192, v36
    v_mov_b32 v193, v37
    v_mov_b32 v194, v38
    v_mov_b32 v195, v39
    v_mov_b32 v196, v40
    v_mov_b32 v197, v41
    v_mov_b32 v198, v42
    v_mov_b32 v199, v43
    v_mov_b32 v200, v44
    v_mov_b32 v201, v45
    v_mov_b32 v202, v46
    v_mov_b32 v203, v47
    s_branch K2_XD
K2_X1:
    s_cmp_eq_u32 s26, 2
    s_cbranch_scc0 K2_X2
    ds_write_b128 v7, v[16:19] offset:5120
    ds_write_b128 v7, v[20:23] offset:6144
    ds_write_b128 v7, v[24:27] offset:7168
    ds_write_b128 v7, v[28:31] offset:8192
    ds_write_b128 v7, v[32:35] offset:9216
    ds_write_b128 v7, v[36:39] offset:22528
    ds_write_b128 v7, v[40:43] offset:23552
    ds_write_b128 v7, v[44:47] offset:24576
    ds_write_b128 v7, v[48:51] offset:25600
    ds_write_b128 v7, v[52:55] offset:26624
    ds_write_b128 v10, v[68:71] offset:15360
    ds_write_b128 v10, v[72:75] offset:16384
    ds_write_b128 v10, v[76:79] offset:27648
    ds_write_b128 v10, v[80:83] offset:28672
    ds_write_b128 v10, v[84:87] offset:29696
    ds_write_b128 v10, v[88:91] offset:30720
    ds_write_b128 v10, v[92:95] offset:31744
    v_mov_b32 v192, v56
    v_mov_b32 v193, v57
    v_mov_b32 v194, v58
    v_mov_b32 v195, v59
    v_mov_b32 v196, v60
    v_mov_b32 v197, v61
    v_mov_b32 v198, v62
    v_mov_b32 v199, v63
    v_mov_b32 v200, v64
    v_mov_b32 v201, v65
    v_mov_b32 v202, v66
    v_mov_b32 v203, v67
    s_branch K2_XD
K2_X2:
    s_cmp_eq_u32 s26, 3
    s_cbranch_scc0 K2_X3
    ds_write_b128 v7, v[16:19] offset:10240
    ds_write_b128 v7, v[20:23] offset:11264
    ds_write_b128 v7, v[24:27] offset:12288
    ds_write_b128 v7, v[28:31] offset:13312
    ds_write_b128 v7, v[32:35] offset:14336
    ds_write_b128 v7, v[36:39] offset:27648
    ds_write_b128 v7, v[40:43] offset:28672
    ds_write_b128 v7, v[44:47] offset:29696
    ds_write_b128 v7, v[48:51] offset:30720
    ds_write_b128 v7, v[52:55] offset:31744
    ds_write_b128 v10, v[56:59] offset:10240
    ds_write_b128 v10, v[60:63] offset:11264
    ds_write_b128 v10, v[64:67] offset:12288
    ds_write_b128 v10, v[68:71] offset:13312
    ds_write_b128 v10, v[72:75] offset:14336
    ds_write_b128 v10, v[88:91] offset:32768
    ds_write_b128 v10, v[92:95] offset:33792
    v_mov_b32 v192, v76
    v_mov_b32 v193, v77
    v_mov_b32 v194, v78
    v_mov_b32 v195, v79
    v_mov_b32 v196, v80
    v_mov_b32 v197, v81
    v_mov_b32 v198, v82
    v_mov_b32 v199, v83
    v_mov_b32 v200, v84
    v_mov_b32 v201, v85
    v_mov_b32 v202, v86
    v_mov_b32 v203, v87
    s_branch K2_XD
K2_X3:
K2_XD:
    s_mul_i32 s50, s26, 17408
    v_add_u32 v7, s50, v7
    s_mul_i32 s50, s26, 5120
    v_add_u32 v9, s50, v2
    s_add_u32 s50, s45, s26
    s_mul_i32 s50, s50, 20480
    s_mul_i32 s51, s46, 32
    s_add_u32 s50, s50, s51
    v_mul_u32_u24 v8, 1280, v4
    v_lshl_add_u32 v8, v5, 3, v8
    s_waitcnt lgkmcnt(0)
    s_barrier
    v_add_u32 v10, 40960, v9
    ds_read_b128 v[96:99], v7 offset:0
    ds_read_b128 v[100:103], v7 offset:1024
    ds_read_b128 v[104:107], v7 offset:2048
    ds_read_b128 v[108:111], v7 offset:5120
    ds_read_b128 v[112:115], v7 offset:6144
    ds_read_b128 v[116:119], v7 offset:7168
    ds_read_b128 v[120:123], v7 offset:10240
    ds_read_b128 v[124:127], v7 offset:11264
    ds_read_b128 v[128:131], v7 offset:12288
    ds_read_b128 v[132:135], v9 offset:0
    ds_read_b128 v[136:139], v9 offset:1024
    ds_read_b128 v[140:143], v9 offset:2048
    ds_read_b128 v[144:147], v9 offset:20480
    ds_read_b128 v[148:151], v9 offset:21504
    ds_read_b128 v[152:155], v9 offset:22528
    ds_read_b128 v[156:159], v10 offset:0
    ds_read_b128 v[160:163], v10 offset:1024
    ds_read_b128 v[164:167], v10 offset:2048
    ds_read_b128 v[168:171], v10 offset:20480
    ds_read_b128 v[172:175], v10 offset:21504
    ds_read_b128 v[176:179], v10 offset:22528
    s_waitcnt lgkmcnt(15)
    v_pk_add_f32 v[192:193], v[192:193], v[96:97]
    v_pk_add_f32 v[194:195], v[194:195], v[98:99]
    v_pk_add_f32 v[196:197], v[196:197], v[100:101]
    v_pk_add_f32 v[198:199], v[198:199], v[102:103]
    v_pk_add_f32 v[200:201], v[200:201], v[104:105]
    v_pk_add_f32 v[202:203], v[202:203], v[106:107]
    s_waitcnt lgkmcnt(15)
    v_pk_add_f32 v[192:193], v[192:193], v[108:109]
    v_pk_add_f32 v[194:195], v[194:195], v[110:111]
    v_pk_add_f32 v[196:197], v[196:197], v[112:113]
    v_pk_add_f32 v[198:199], v[198:199], v[114:115]
    v_pk_add_f32 v[200:201], v[200:201], v[116:117]
    v_pk_add_f32 v[202:203], v[202:203], v[118:119]
    s_waitcnt lgkmcnt(12)
    v_pk_add_f32 v[192:193], v[192:193], v[120:121]
    v_pk_add_f32 v[194:195], v[194:195], v[122:123]
    v_pk_add_f32 v[196:197], v[196:197], v[124:125]
    v_pk_add_f32 v[198:199], v[198:199], v[126:127]
    v_pk_add_f32 v[200:201], v[200:201], v[128:129]
    v_pk_add_f32 v[202:203], v[202:203], v[130:131]
    s_waitcnt lgkmcnt(9)
    v_pk_add_f32 v[192:193], v[192:193], v[132:133]
    v_pk_add_f32 v[194:195], v[194:195], v[134:135]
    v_pk_add_f32 v[196:197], v[196:197], v[136:137]
    v_pk_add_f32 v[198:199], v[198:199], v[138:139]
    v_pk_add_f32 v[200:201], v[200:201], v[140:141]
    v_pk_add_f32 v[202:203], v[202:203], v[142:143]
    s_waitcnt lgkmcnt(6)
    v_pk_add_f32 v[192:193], v[192:193], v[144:145]
    v_pk_add_f32 v[194:195], v[194:195], v[146:147]
    v_pk_add_f32 v[196:197], v[196:197], v[148:149]
    v_pk_add_f32 v[198:199], v[198:199], v[150:151]
    v_pk_add_f32 v[200:201], v[200:201], v[152:153]
    v_pk_add_f32 v[202:203], v[202:203], v[154:155]
    s_waitcnt lgkmcnt(3)
    v_pk_add_f32 v[192:193], v[192:193], v[156:157]
    v_pk_add_f32 v[194:195], v[194:195], v[158:159]
    v_pk_add_f32 v[196:197], v[196:197], v[160:161]
    v_pk_add_f32 v[198:199], v[198:199], v[162:163]
    v_pk_add_f32 v[200:201], v[200:201], v[164:165]
    v_pk_add_f32 v[202:203], v[202:203], v[166:167]
    s_waitcnt lgkmcnt(0)
    v_pk_add_f32 v[192:193], v[192:193], v[168:169]
    v_pk_add_f32 v[194:195], v[194:195], v[170:171]
    v_pk_add_f32 v[196:197], v[196:197], v[172:173]
    v_pk_add_f32 v[198:199], v[198:199], v[174:175]
    v_pk_add_f32 v[200:201], v[200:201], v[176:177]
    v_pk_add_f32 v[202:203], v[202:203], v[178:179]
    v_cvt_pk_bf16_f32 v192, v192, v193
    v_cvt_pk_bf16_f32 v193, v194, v195
    buffer_store_dwordx2 v[192:193], v8, s[28:31], s50 offen offset:0
    v_cvt_pk_bf16_f32 v196, v196, v197
    v_cvt_pk_bf16_f32 v197, v198, v199
    buffer_store_dwordx2 v[196:197], v8, s[28:31], s50 offen offset:32
    v_cvt_pk_bf16_f32 v200, v200, v201
    v_cvt_pk_bf16_f32 v201, v202, v203
    buffer_store_dwordx2 v[200:201], v8, s[28:31], s50 offen offset:64
    s_endpgm
K2_ATT:
    s_setprio 3
    s_sub_u32 s27, s26, 4
    s_mul_i32 s50, s46, 20
    s_mul_i32 s51, s27, 5
    s_add_u32 s50, s50, s51
    s_lshl_b32 s50, s50, 10
    s_add_u32 s50, s50, 0xd00000
    s_mul_i32 s48, s27, 640
    s_add_u32 s48, s48, 0xe1a000
    v_lshlrev_b32 v7, 4, v5
    buffer_load_dwordx4 v[120:123], v7, s[36:39], s48 offen offset:0
    buffer_load_dwordx4 v[124:127], v7, s[36:39], s48 offen offset:64
    buffer_load_dwordx4 v[128:131], v7, s[36:39], s48 offen offset:128
    buffer_load_dwordx4 v[132:135], v7, s[36:39], s48 offen offset:192
    buffer_load_dwordx4 v[136:139], v7, s[36:39], s48 offen offset:256
    buffer_load_dwordx4 v[140:143], v7, s[36:39], s48 offen offset:320
    buffer_load_dwordx4 v[144:147], v7, s[36:39], s48 offen offset:384
    buffer_load_dwordx4 v[148:151], v7, s[36:39], s48 offen offset:448
    buffer_load_dwordx4 v[152:155], v7, s[36:39], s48 offen offset:512
    buffer_load_dwordx4 v[156:159], v7, s[36:39], s48 offen offset:576
    buffer_load_dword v252, v6, s[36:39], s47 offen offset:0
    buffer_load_dword v253, v6, s[36:39], s47 offen offset:64
    buffer_load_dword v254, v6, s[36:39], s47 offen offset:128
    buffer_load_dword v255, v6, s[36:39], s47 offen offset:192
    s_mul_i32 s52, s27, 20480
    s_mul_i32 s53, s45, 74
    s_mul_i32 s54, s27, 5
    s_add_u32 s53, s53, s54
    s_add_u32 s53, s53, 54
    s_lshl_b32 s53, s53, 10
    s_add_u32 s54, s53, 0
    s_add_u32 m0, s52, 0
    s_nop 0
    buffer_load_dwordx4 v2, s[36:39], s54 offen lds
    s_add_u32 s54, s53, 1024
    s_add_u32 m0, s52, 1024
    s_nop 0
    buffer_load_dwordx4 v2, s[36:39], s54 offen lds
    s_add_u32 s54, s53, 2048
    s_add_u32 m0, s52, 2048
    s_nop 0
    buffer_load_dwordx4 v2, s[36:39], s54 offen lds
    s_add_u32 s54, s53, 3072
    s_add_u32 m0, s52, 3072
    s_nop 0
    buffer_load_dwordx4 v2, s[36:39], s54 offen lds
    s_add_u32 s54, s53, 4096
    s_add_u32 m0, s52, 4096
    s_nop 0
    buffer_load_dwordx4 v2, s[36:39], s54 offen lds
    s_add_u32 s54, s53, 75776
    s_add_u32 m0, s52, 5120
    s_nop 0
    buffer_load_dwordx4 v2, s[36:39], s54 offen lds
    s_add_u32 s54, s53, 76800
    s_add_u32 m0, s52, 6144
    s_nop 0
    buffer_load_dwordx4 v2, s[36:39], s54 offen lds
    s_add_u32 s54, s53, 77824
    s_add_u32 m0, s52, 7168
    s_nop 0
    buffer_load_dwordx4 v2, s[36:39], s54 offen lds
    s_add_u32 s54, s53, 78848
    s_add_u32 m0, s52, 8192
    s_nop 0
    buffer_load_dwordx4 v2, s[36:39], s54 offen lds
    s_add_u32 s54, s53, 79872
    s_add_u32 m0, s52, 9216
    s_nop 0
    buffer_load_dwordx4 v2, s[36:39], s54 offen lds
    s_add_u32 s54, s53, 151552
    s_add_u32 m0, s52, 10240
    s_nop 0
    buffer_load_dwordx4 v2, s[36:39], s54 offen lds
    s_add_u32 s54, s53, 152576
    s_add_u32 m0, s52, 11264
    s_nop 0
    buffer_load_dwordx4 v2, s[36:39], s54 offen lds
    s_add_u32 s54, s53, 153600
    s_add_u32 m0, s52, 12288
    s_nop 0
    buffer_load_dwordx4 v2, s[36:39], s54 offen lds
    s_add_u32 s54, s53, 154624
    s_add_u32 m0, s52, 13312
    s_nop 0
    buffer_load_dwordx4 v2, s[36:39], s54 offen lds
    s_add_u32 s54, s53, 155648
    s_add_u32 m0, s52, 14336
    s_nop 0
    buffer_load_dwordx4 v2, s[36:39], s54 offen lds
    s_add_u32 s54, s53, 227328
    s_add_u32 m0, s52, 15360
    s_nop 0
    buffer_load_dwordx4 v2, s[36:39], s54 offen lds
    s_add_u32 s54, s53, 228352
    s_add_u32 m0, s52, 16384
    s_nop 0
    buffer_load_dwordx4 v2, s[36:39], s54 offen lds
    s_add_u32 s54, s53, 229376
    s_add_u32 m0, s52, 17408
    s_nop 0
    buffer_load_dwordx4 v2, s[36:39], s54 offen lds
    s_add_u32 s54, s53, 230400
    s_add_u32 m0, s52, 18432
    s_nop 0
    buffer_load_dwordx4 v2, s[36:39], s54 offen lds
    s_add_u32 s54, s53, 231424
    s_add_u32 m0, s52, 19456
    s_nop 0
    buffer_load_dwordx4 v2, s[36:39], s54 offen lds
    v_mov_b32 v16, 0
    v_mov_b32 v17, 0
    v_mov_b32 v18, 0
    v_mov_b32 v19, 0
    v_mov_b32 v20, 0
    v_mov_b32 v21, 0
    v_mov_b32 v22, 0
    v_mov_b32 v23, 0
    v_mov_b32 v24, 0
    v_mov_b32 v25, 0
    v_mov_b32 v26, 0
    v_mov_b32 v27, 0
    v_mov_b32 v28, 0
    v_mov_b32 v29, 0
    v_mov_b32 v30, 0
    v_mov_b32 v31, 0
    v_mov_b32 v32, 0
    v_mov_b32 v33, 0
    v_mov_b32 v34, 0
    v_mov_b32 v35, 0
    v_mov_b32 v36, 0
    v_mov_b32 v37, 0
    v_mov_b32 v38, 0
    v_mov_b32 v39, 0
    v_mov_b32 v40, 0
    v_mov_b32 v41, 0
    v_mov_b32 v42, 0
    v_mov_b32 v43, 0
    v_mov_b32 v44, 0
    v_mov_b32 v45, 0
    v_mov_b32 v46, 0
    v_mov_b32 v47, 0
    v_mov_b32 v48, 0
    v_mov_b32 v49, 0
    v_mov_b32 v50, 0
    v_mov_b32 v51, 0
    v_mov_b32 v52, 0
    v_mov_b32 v53, 0
    v_mov_b32 v54, 0
    v_mov_b32 v55, 0
    v_mov_b32 v56, 0
    v_mov_b32 v57, 0
    v_mov_b32 v58, 0
    v_mov_b32 v59, 0
    v_mov_b32 v60, 0
    v_mov_b32 v61, 0
    v_mov_b32 v62, 0
    v_mov_b32 v63, 0
    v_mov_b32 v64, 0
    v_mov_b32 v65, 0
    v_mov_b32 v66, 0
    v_mov_b32 v67, 0
    v_mov_b32 v68, 0
    v_mov_b32 v69, 0
    v_mov_b32 v70, 0
    v_mov_b32 v71, 0
    v_mov_b32 v72, 0
    v_mov_b32 v73, 0
    v_mov_b32 v74, 0
    v_mov_b32 v75, 0
    v_mov_b32 v76, 0
    v_mov_b32 v77, 0
    v_mov_b32 v78, 0
    v_mov_b32 v79, 0
    v_mov_b32 v80, 0
    v_mov_b32 v81, 0
    v_mov_b32 v82, 0
    v_mov_b32 v83, 0
    v_mov_b32 v84, 0
    v_mov_b32 v85, 0
    v_mov_b32 v86, 0
    v_mov_b32 v87, 0
    v_mov_b32 v88, 0
    v_mov_b32 v89, 0
    v_mov_b32 v90, 0
    v_mov_b32 v91, 0
    v_mov_b32 v92, 0
    v_mov_b32 v93, 0
    v_mov_b32 v94, 0
    v_mov_b32 v95, 0
    v_mov_b32 v96, 0
    v_mov_b32 v97, 0
    v_mov_b32 v98, 0
    v_mov_b32 v99, 0
    v_mov_b32 v100, 0
    v_mov_b32 v101, 0
    v_mov_b32 v102, 0
    v_mov_b32 v103, 0
    v_mov_b32 v104, 0
    v_mov_b32 v105, 0
    v_mov_b32 v106, 0
    v_mov_b32 v107, 0
    v_mov_b32 v108, 0
    v_mov_b32 v109, 0
    v_mov_b32 v110, 0
    v_mov_b32 v111, 0
    v_mov_b32 v112, 0
    v_mov_b32 v113, 0
    v_mov_b32 v114, 0
    v_mov_b32 v115, 0
    v_mov_b32 v116, 0
    v_mov_b32 v117, 0
    v_mov_b32 v118, 0
    v_mov_b32 v119, 0
    s_mul_i32 s49, s27, 26624
    s_add_u32 s49, s49, 0xe00000
    buffer_load_dwordx4 v[16:19], v2, s[36:39], s49 offen offset:0
    s_mov_b32 exec_lo, 0xffff
    s_mov_b32 exec_hi, 0x0
    buffer_load_dwordx4 v[20:23], v2, s[36:39], s49 offen offset:1024
    s_mov_b64 exec, -1
    s_mov_b32 exec_lo, 0xf000f
    s_mov_b32 exec_hi, 0xf000f
    buffer_load_dwordx4 v[24:27], v2, s[36:39], s49 offen offset:2048
    s_mov_b64 exec, -1
    s_mov_b32 exec_lo, 0xfff0000f
    s_mov_b32 exec_hi, 0xfff0fff0
    buffer_load_dwordx4 v[28:31], v2, s[36:39], s49 offen offset:3072
    s_mov_b64 exec, -1
    s_add_u32 s49, s49, 4096
    s_mov_b32 exec_lo, 0xfff0fff0
    s_mov_b32 exec_hi, 0x0
    buffer_load_dwordx4 v[32:35], v2, s[36:39], s49 offen offset:0
    s_mov_b64 exec, -1
    s_mov_b32 exec_lo, 0xff0000
    s_mov_b32 exec_hi, 0xff00ff
    buffer_load_dwordx4 v[36:39], v2, s[36:39], s49 offen offset:1024
    s_mov_b64 exec, -1
    s_mov_b32 exec_lo, 0xff00ff
    s_mov_b32 exec_hi, 0xff00ff00
    buffer_load_dwordx4 v[40:43], v2, s[36:39], s49 offen offset:2048
    s_mov_b64 exec, -1
    s_mov_b32 exec_lo, 0xff00ff00
    s_mov_b32 exec_hi, 0xff00
    buffer_load_dwordx4 v[44:47], v2, s[36:39], s49 offen offset:3072
    s_mov_b64 exec, -1
    s_add_u32 s49, s49, 4096
    s_mov_b32 exec_lo, 0x0
    s_mov_b32 exec_hi, 0xfff0fff
    buffer_load_dwordx4 v[48:51], v2, s[36:39], s49 offen offset:0
    s_mov_b64 exec, -1
    s_mov_b32 exec_lo, 0xfff0fff
    s_mov_b32 exec_hi, 0xf0000fff
    buffer_load_dwordx4 v[52:55], v2, s[36:39], s49 offen offset:1024
    s_mov_b64 exec, -1
    s_mov_b32 exec_lo, 0xf000f000
    s_mov_b32 exec_hi, 0xf000f000
    buffer_load_dwordx4 v[56:59], v2, s[36:39], s49 offen offset:2048
    s_mov_b64 exec, -1
    s_mov_b32 exec_lo, 0x0
    s_mov_b32 exec_hi, 0xffff0000
    buffer_load_dwordx4 v[60:63], v2, s[36:39], s49 offen offset:3072
    s_mov_b64 exec, -1
    s_add_u32 s49, s49, 4096
    buffer_load_dwordx4 v[64:67], v2, s[36:39], s49 offen offset:0
    buffer_load_dwordx4 v[68:71], v2, s[36:39], s49 offen offset:1024
    s_mov_b32 exec_lo, 0xffff
    s_mov_b32 exec_hi, 0x0
    buffer_load_dwordx4 v[72:75], v2, s[36:39], s49 offen offset:2048
    s_mov_b64 exec, -1
    s_mov_b32 exec_lo, 0xf000f
    s_mov_b32 exec_hi, 0xf000f
    buffer_load_dwordx4 v[76:79], v2, s[36:39], s49 offen offset:3072
    s_mov_b64 exec, -1
    s_add_u32 s49, s49, 4096
    s_mov_b32 exec_lo, 0xfff0000f
    s_mov_b32 exec_hi, 0xfff0fff0
    buffer_load_dwordx4 v[80:83], v2, s[36:39], s49 offen offset:0
    s_mov_b64 exec, -1
    s_mov_b32 exec_lo, 0xfff0fff0
    s_mov_b32 exec_hi, 0x0
    buffer_load_dwordx4 v[84:87], v2, s[36:39], s49 offen offset:1024
    s_mov_b64 exec, -1
    s_mov_b32 exec_lo, 0xff0000
    s_mov_b32 exec_hi, 0xff00ff
    buffer_load_dwordx4 v[88:91], v2, s[36:39], s49 offen offset:2048
    s_mov_b64 exec, -1
    s_mov_b32 exec_lo, 0xff00ff
    s_mov_b32 exec_hi, 0xff00ff00
    buffer_load_dwordx4 v[92:95], v2, s[36:39], s49 offen offset:3072
    s_mov_b64 exec, -1
    s_add_u32 s49, s49, 4096
    s_mov_b32 exec_lo, 0xff00ff00
    s_mov_b32 exec_hi, 0xff00
    buffer_load_dwordx4 v[96:99], v2, s[36:39], s49 offen offset:0
    s_mov_b64 exec, -1
    s_mov_b32 exec_lo, 0x0
    s_mov_b32 exec_hi, 0xfff0fff
    buffer_load_dwordx4 v[100:103], v2, s[36:39], s49 offen offset:1024
    s_mov_b64 exec, -1
    s_mov_b32 exec_lo, 0xfff0fff
    s_mov_b32 exec_hi, 0xf0000fff
    buffer_load_dwordx4 v[104:107], v2, s[36:39], s49 offen offset:2048
    s_mov_b64 exec, -1
    s_mov_b32 exec_lo, 0xf000f000
    s_mov_b32 exec_hi, 0xf000f000
    buffer_load_dwordx4 v[108:111], v2, s[36:39], s49 offen offset:3072
    s_mov_b64 exec, -1
    s_add_u32 s49, s49, 4096
    s_mov_b32 exec_lo, 0x0
    s_mov_b32 exec_hi, 0xffff0000
    buffer_load_dwordx4 v[112:115], v2, s[36:39], s49 offen offset:0
    s_mov_b64 exec, -1
    buffer_load_dwordx4 v[116:119], v2, s[36:39], s49 offen offset:1024
    s_add_u32 s51, s50, 0
    buffer_load_dwordx4 v[192:195], v2, s[36:39], s51 offen offset:0
    buffer_load_dwordx4 v[196:199], v2, s[36:39], s51 offen offset:1024
    buffer_load_dwordx4 v[200:203], v2, s[36:39], s51 offen offset:2048
    buffer_load_dwordx4 v[204:207], v2, s[36:39], s51 offen offset:3072
    s_add_u32 s51, s51, 4096
    buffer_load_dwordx4 v[208:211], v2, s[36:39], s51 offen
    s_add_u32 s51, s50, 20480
    buffer_load_dwordx4 v[212:215], v2, s[36:39], s51 offen offset:0
    buffer_load_dwordx4 v[216:219], v2, s[36:39], s51 offen offset:1024
    buffer_load_dwordx4 v[220:223], v2, s[36:39], s51 offen offset:2048
    buffer_load_dwordx4 v[224:227], v2, s[36:39], s51 offen offset:3072
    s_add_u32 s51, s51, 4096
    buffer_load_dwordx4 v[228:231], v2, s[36:39], s51 offen
    s_lshl_b32 s55, s27, 11
    s_add_u32 s55, s55, 151552
    v_add_u32 v9, s52, v2
    v_lshlrev_b32 v10, 5, v4
    v_add_u32 v10, s55, v10
    v_lshl_add_u32 v8, v5, 4, v10
    v_cmp_le_u32 vcc, 1, v5
    s_nop 1
    v_cndmask_b32 v11, 0, 4, vcc
    v_add_u32 v11, v10, v11
    v_cmp_le_u32 vcc, 2, v5
    s_nop 1
    v_cndmask_b32 v12, 0, 4, vcc
    v_add_u32 v12, v10, v12
    v_cmp_le_u32 vcc, 3, v5
    s_nop 1
    v_cndmask_b32 v13, 0, 4, vcc
    v_add_u32 v13, v10, v13
    s_waitcnt vmcnt(60)
    v_cvt_pk_bf16_f32 v160, v120, v121
    v_cvt_pk_bf16_f32 v161, v122, v123
    v_cvt_pk_bf16_f32 v162, v124, v125
    v_cvt_pk_bf16_f32 v163, v126, v127
    s_mov_b32 s56, 0x10001
    s_mov_b32 s57, 0x10001
    v_cndmask_b32 v160, 0, v160, s[56:57]
    v_cndmask_b32 v161, 0, v161, s[56:57]
    s_mov_b32 s56, 0x20001
    s_mov_b32 s57, 0x20002
    v_cndmask_b32 v162, 0, v162, s[56:57]
    v_cndmask_b32 v163, 0, v163, s[56:57]
    v_cvt_pk_bf16_f32 v164, v128, v129
    v_cvt_pk_bf16_f32 v165, v130, v131
    v_cvt_pk_bf16_f32 v166, v132, v133
    v_cvt_pk_bf16_f32 v167, v134, v135
    s_mov_b32 s56, 0x20002
    s_mov_b32 s57, 0x40004
    v_cndmask_b32 v164, 0, v164, s[56:57]
    v_cndmask_b32 v165, 0, v165, s[56:57]
    s_mov_b32 s56, 0x40004
    s_mov_b32 s57, 0x80004
    v_cndmask_b32 v166, 0, v166, s[56:57]
    v_cndmask_b32 v167, 0, v167, s[56:57]
    v_cvt_pk_bf16_f32 v168, v136, v137
    v_cvt_pk_bf16_f32 v169, v138, v139
    v_cvt_pk_bf16_f32 v170, v140, v141
    v_cvt_pk_bf16_f32 v171, v142, v143
    s_mov_b32 s56, 0x80008
    s_mov_b32 s57, 0x80008
    v_cndmask_b32 v168, 0, v168, s[56:57]
    v_cndmask_b32 v169, 0, v169, s[56:57]
    s_mov_b32 s56, 0x100010
    s_mov_b32 s57, 0x100010
    v_cndmask_b32 v170, 0, v170, s[56:57]
    v_cndmask_b32 v171, 0, v171, s[56:57]
    v_cvt_pk_bf16_f32 v172, v144, v145
    v_cvt_pk_bf16_f32 v173, v146, v147
    v_cvt_pk_bf16_f32 v174, v148, v149
    v_cvt_pk_bf16_f32 v175, v150, v151
    s_mov_b32 s56, 0x200010
    s_mov_b32 s57, 0x200020
    v_cndmask_b32 v172, 0, v172, s[56:57]
    v_cndmask_b32 v173, 0, v173, s[56:57]
    s_mov_b32 s56, 0x200020
    s_mov_b32 s57, 0x400040
    v_cndmask_b32 v174, 0, v174, s[56:57]
    v_cndmask_b32 v175, 0, v175, s[56:57]
    v_cvt_pk_bf16_f32 v176, v152, v153
    v_cvt_pk_bf16_f32 v177, v154, v155
    v_cvt_pk_bf16_f32 v178, v156, v157
    v_cvt_pk_bf16_f32 v179, v158, v159
    s_mov_b32 s56, 0x400040
    s_mov_b32 s57, 0x800040
    v_cndmask_b32 v176, 0, v176, s[56:57]
    v_cndmask_b32 v177, 0, v177, s[56:57]
    s_mov_b32 s56, 0x800080
    s_mov_b32 s57, 0x800080
    v_cndmask_b32 v178, 0, v178, s[56:57]
    v_cndmask_b32 v179, 0, v179, s[56:57]
    s_waitcnt vmcnt(36)
    ds_read_b128 v[120:123], v9 offset:0
    ds_read_b128 v[124:127], v9 offset:1024
    ds_read_b128 v[128:131], v9 offset:2048
    ds_read_b128 v[132:135], v9 offset:3072
    ds_read_b128 v[136:139], v9 offset:4096
    ds_read_b128 v[140:143], v9 offset:5120
    ds_read_b128 v[144:147], v9 offset:6144
    ds_read_b128 v[148:151], v9 offset:7168
    ds_read_b128 v[152:155], v9 offset:8192
    ds_read_b128 v[156:159], v9 offset:9216
    s_waitcnt lgkmcnt(5)
    v_mfma_f32_16x16x32_bf16 v[232:235], v[160:163], v[120:123], 0
    v_mfma_f32_16x16x32_bf16 v[232:235], v[164:167], v[124:127], v[232:235]
    v_mfma_f32_16x16x32_bf16 v[232:235], v[168:171], v[128:131], v[232:235]
    v_mfma_f32_16x16x32_bf16 v[232:235], v[172:175], v[132:135], v[232:235]
    v_mfma_f32_16x16x32_bf16 v[232:235], v[176:179], v[136:139], v[232:235]
    ds_read_b128 v[120:123], v9 offset:10240
    ds_read_b128 v[124:127], v9 offset:11264
    ds_read_b128 v[128:131], v9 offset:12288
    ds_read_b128 v[132:135], v9 offset:13312
    ds_read_b128 v[136:139], v9 offset:14336
    s_waitcnt lgkmcnt(5)
    v_mfma_f32_16x16x32_bf16 v[236:239], v[160:163], v[140:143], 0
    v_mfma_f32_16x16x32_bf16 v[236:239], v[164:167], v[144:147], v[236:239]
    v_mfma_f32_16x16x32_bf16 v[236:239], v[168:171], v[148:151], v[236:239]
    v_mfma_f32_16x16x32_bf16 v[236:239], v[172:175], v[152:155], v[236:239]
    v_mfma_f32_16x16x32_bf16 v[236:239], v[176:179], v[156:159], v[236:239]
    ds_read_b128 v[140:143], v9 offset:15360
    ds_read_b128 v[144:147], v9 offset:16384
    ds_read_b128 v[148:151], v9 offset:17408
    ds_read_b128 v[152:155], v9 offset:18432
    ds_read_b128 v[156:159], v9 offset:19456
    s_waitcnt lgkmcnt(5)
    v_mfma_f32_16x16x32_bf16 v[240:243], v[160:163], v[120:123], 0
    v_mfma_f32_16x16x32_bf16 v[240:243], v[164:167], v[124:127], v[240:243]
    v_mfma_f32_16x16x32_bf16 v[240:243], v[168:171], v[128:131], v[240:243]
    v_mfma_f32_16x16x32_bf16 v[240:243], v[172:175], v[132:135], v[240:243]
    v_mfma_f32_16x16x32_bf16 v[240:243], v[176:179], v[136:139], v[240:243]
    s_waitcnt lgkmcnt(0)
    v_mfma_f32_16x16x32_bf16 v[244:247], v[160:163], v[140:143], 0
    v_mfma_f32_16x16x32_bf16 v[244:247], v[164:167], v[144:147], v[244:247]
    v_mfma_f32_16x16x32_bf16 v[244:247], v[168:171], v[148:151], v[244:247]
    v_mfma_f32_16x16x32_bf16 v[244:247], v[172:175], v[152:155], v[244:247]
    v_mfma_f32_16x16x32_bf16 v[244:247], v[176:179], v[156:159], v[244:247]
    ds_read_b128 v[120:123], v9 offset:0
    ds_read_b128 v[124:127], v9 offset:1024
    ds_read_b128 v[128:131], v9 offset:2048
    ds_read_b128 v[132:135], v9 offset:3072
    ds_read_b128 v[136:139], v9 offset:4096
    ds_read_b128 v[140:143], v9 offset:5120
    ds_read_b128 v[144:147], v9 offset:6144
    ds_read_b128 v[148:151], v9 offset:7168
    ds_read_b128 v[152:155], v9 offset:8192
    ds_read_b128 v[156:159], v9 offset:9216
    s_mov_b32 s56, 0x358637bd
    v_add_f32 v232, s56, v232
    v_add_f32 v233, s56, v233
    v_add_f32 v234, s56, v234
    v_add_f32 v235, s56, v235
    v_add_f32 v236, s56, v236
    v_add_f32 v237, s56, v237
    v_add_f32 v238, s56, v238
    v_add_f32 v239, s56, v239
    v_add_f32 v240, s56, v240
    v_add_f32 v241, s56, v241
    v_add_f32 v242, s56, v242
    v_add_f32 v243, s56, v243
    v_add_f32 v244, s56, v244
    v_add_f32 v245, s56, v245
    v_add_f32 v246, s56, v246
    v_add_f32 v247, s56, v247
    v_rcp_f32 v232, v232
    v_rcp_f32 v233, v233
    v_rcp_f32 v234, v234
    v_rcp_f32 v235, v235
    v_rcp_f32 v236, v236
    v_rcp_f32 v237, v237
    v_rcp_f32 v238, v238
    v_rcp_f32 v239, v239
    v_rcp_f32 v240, v240
    v_rcp_f32 v241, v241
    v_rcp_f32 v242, v242
    v_rcp_f32 v243, v243
    v_rcp_f32 v244, v244
    v_rcp_f32 v245, v245
    v_rcp_f32 v246, v246
    v_rcp_f32 v247, v247
    s_nop 0
    v_mul_f32 v232, v252, v232
    v_mul_f32 v233, v252, v233
    v_mul_f32 v234, v252, v234
    v_mul_f32 v235, v252, v235
    v_mul_f32 v236, v253, v236
    v_mul_f32 v237, v253, v237
    v_mul_f32 v238, v253, v238
    v_mul_f32 v239, v253, v239
    v_mul_f32 v240, v254, v240
    v_mul_f32 v241, v254, v241
    v_mul_f32 v242, v254, v242
    v_mul_f32 v243, v254, v243
    v_mul_f32 v244, v255, v244
    v_mul_f32 v245, v255, v245
    v_mul_f32 v246, v255, v246
    v_mul_f32 v247, v255, v247
    s_mov_b32 exec_lo, -1
    s_mov_b32 exec_hi, 0
    ds_write_b128 v8, v[232:235] offset:0
    ds_write_b128 v8, v[236:239] offset:512
    ds_write_b128 v8, v[240:243] offset:1024
    ds_write_b128 v8, v[244:247] offset:1536
    s_mov_b64 exec, -1
    s_waitcnt lgkmcnt(0)
    ds_read_b32 v180, v10 offset:0
    ds_read_b32 v181, v11 offset:0
    ds_read_b32 v182, v12 offset:4
    ds_read_b32 v183, v13 offset:8
    ds_read_b32 v184, v10 offset:12
    ds_read_b32 v185, v10 offset:16
    ds_read_b32 v186, v11 offset:16
    ds_read_b32 v187, v12 offset:20
    ds_read_b32 v188, v13 offset:24
    ds_read_b32 v189, v10 offset:28
    ds_read_b32 v232, v10 offset:512
    ds_read_b32 v233, v11 offset:512
    ds_read_b32 v234, v12 offset:516
    ds_read_b32 v235, v13 offset:520
    ds_read_b32 v236, v10 offset:524
    ds_read_b32 v237, v10 offset:528
    ds_read_b32 v238, v11 offset:528
    ds_read_b32 v239, v12 offset:532
    ds_read_b32 v240, v13 offset:536
    ds_read_b32 v241, v10 offset:540
    s_waitcnt lgkmcnt(10)
    v_lshlrev_b32 v190, 16, v120
    v_and_b32 v191, 0xffff0000, v120
    v_pk_mul_f32 v[190:191], v[190:191], v[180:181] op_sel:[0,0] op_sel_hi:[1,0]
    v_cvt_pk_bf16_f32 v120, v190, v191
    v_lshlrev_b32 v242, 16, v121
    v_and_b32 v243, 0xffff0000, v121
    v_pk_mul_f32 v[242:243], v[242:243], v[180:181] op_sel:[0,0] op_sel_hi:[1,0]
    v_cvt_pk_bf16_f32 v121, v242, v243
    v_lshlrev_b32 v244, 16, v122
    v_and_b32 v245, 0xffff0000, v122
    v_pk_mul_f32 v[244:245], v[244:245], v[180:181] op_sel:[0,1] op_sel_hi:[1,1]
    v_cvt_pk_bf16_f32 v122, v244, v245
    v_lshlrev_b32 v246, 16, v123
    v_and_b32 v247, 0xffff0000, v123
    v_pk_mul_f32 v[246:247], v[246:247], v[180:181] op_sel:[0,1] op_sel_hi:[1,1]
    v_cvt_pk_bf16_f32 v123, v246, v247
    v_lshlrev_b32 v190, 16, v124
    v_and_b32 v191, 0xffff0000, v124
    v_pk_mul_f32 v[190:191], v[190:191], v[182:183] op_sel:[0,0] op_sel_hi:[1,0]
    v_cvt_pk_bf16_f32 v124, v190, v191
    v_lshlrev_b32 v242, 16, v125
    v_and_b32 v243, 0xffff0000, v125
    v_pk_mul_f32 v[242:243], v[242:243], v[182:183] op_sel:[0,0] op_sel_hi:[1,0]
    v_cvt_pk_bf16_f32 v125, v242, v243
    v_lshlrev_b32 v244, 16, v126
    v_and_b32 v245, 0xffff0000, v126
    v_pk_mul_f32 v[244:245], v[244:245], v[182:183] op_sel:[0,1] op_sel_hi:[1,1]
    v_cvt_pk_bf16_f32 v126, v244, v245
    v_lshlrev_b32 v246, 16, v127
    v_and_b32 v247, 0xffff0000, v127
    v_pk_mul_f32 v[246:247], v[246:247], v[182:183] op_sel:[0,1] op_sel_hi:[1,1]
    v_cvt_pk_bf16_f32 v127, v246, v247
    v_lshlrev_b32 v190, 16, v128
    v_and_b32 v191, 0xffff0000, v128
    v_pk_mul_f32 v[190:191], v[190:191], v[184:185] op_sel:[0,0] op_sel_hi:[1,0]
    v_cvt_pk_bf16_f32 v128, v190, v191
    v_lshlrev_b32 v242, 16, v129
    v_and_b32 v243, 0xffff0000, v129
    v_pk_mul_f32 v[242:243], v[242:243], v[184:185] op_sel:[0,0] op_sel_hi:[1,0]
    v_cvt_pk_bf16_f32 v129, v242, v243
    v_lshlrev_b32 v244, 16, v130
    v_and_b32 v245, 0xffff0000, v130
    v_pk_mul_f32 v[244:245], v[244:245], v[184:185] op_sel:[0,1] op_sel_hi:[1,1]
    v_cvt_pk_bf16_f32 v130, v244, v245
    v_lshlrev_b32 v246, 16, v131
    v_and_b32 v247, 0xffff0000, v131
    v_pk_mul_f32 v[246:247], v[246:247], v[184:185] op_sel:[0,1] op_sel_hi:[1,1]
    v_cvt_pk_bf16_f32 v131, v246, v247
    v_lshlrev_b32 v190, 16, v132
    v_and_b32 v191, 0xffff0000, v132
    v_pk_mul_f32 v[190:191], v[190:191], v[186:187] op_sel:[0,0] op_sel_hi:[1,0]
    v_cvt_pk_bf16_f32 v132, v190, v191
    v_lshlrev_b32 v242, 16, v133
    v_and_b32 v243, 0xffff0000, v133
    v_pk_mul_f32 v[242:243], v[242:243], v[186:187] op_sel:[0,0] op_sel_hi:[1,0]
    v_cvt_pk_bf16_f32 v133, v242, v243
    v_lshlrev_b32 v244, 16, v134
    v_and_b32 v245, 0xffff0000, v134
    v_pk_mul_f32 v[244:245], v[244:245], v[186:187] op_sel:[0,1] op_sel_hi:[1,1]
    v_cvt_pk_bf16_f32 v134, v244, v245
    v_lshlrev_b32 v246, 16, v135
    v_and_b32 v247, 0xffff0000, v135
    v_pk_mul_f32 v[246:247], v[246:247], v[186:187] op_sel:[0,1] op_sel_hi:[1,1]
    v_cvt_pk_bf16_f32 v135, v246, v247
    v_lshlrev_b32 v190, 16, v136
    v_and_b32 v191, 0xffff0000, v136
    v_pk_mul_f32 v[190:191], v[190:191], v[188:189] op_sel:[0,0] op_sel_hi:[1,0]
    v_cvt_pk_bf16_f32 v136, v190, v191
    v_lshlrev_b32 v242, 16, v137
    v_and_b32 v243, 0xffff0000, v137
    v_pk_mul_f32 v[242:243], v[242:243], v[188:189] op_sel:[0,0] op_sel_hi:[1,0]
    v_cvt_pk_bf16_f32 v137, v242, v243
    v_lshlrev_b32 v244, 16, v138
    v_and_b32 v245, 0xffff0000, v138
    v_pk_mul_f32 v[244:245], v[244:245], v[188:189] op_sel:[0,1] op_sel_hi:[1,1]
    v_cvt_pk_bf16_f32 v138, v244, v245
    v_lshlrev_b32 v246, 16, v139
    v_and_b32 v247, 0xffff0000, v139
    v_pk_mul_f32 v[246:247], v[246:247], v[188:189] op_sel:[0,1] op_sel_hi:[1,1]
    v_cvt_pk_bf16_f32 v139, v246, v247
    ds_write_b128 v9, v[120:123] offset:0
    ds_write_b128 v9, v[124:127] offset:1024
    ds_write_b128 v9, v[128:131] offset:2048
    ds_write_b128 v9, v[132:135] offset:3072
    ds_write_b128 v9, v[136:139] offset:4096
    ds_read_b128 v[120:123], v9 offset:10240
    ds_read_b128 v[124:127], v9 offset:11264
    ds_read_b128 v[128:131], v9 offset:12288
    ds_read_b128 v[132:135], v9 offset:13312
    ds_read_b128 v[136:139], v9 offset:14336
    ds_read_b32 v180, v10 offset:1024
    ds_read_b32 v181, v11 offset:1024
    ds_read_b32 v182, v12 offset:1028
    ds_read_b32 v183, v13 offset:1032
    ds_read_b32 v184, v10 offset:1036
    ds_read_b32 v185, v10 offset:1040
    ds_read_b32 v186, v11 offset:1040
    ds_read_b32 v187, v12 offset:1044
    ds_read_b32 v188, v13 offset:1048
    ds_read_b32 v189, v10 offset:1052
    s_waitcnt lgkmcnt(15)
    v_lshlrev_b32 v190, 16, v140
    v_and_b32 v191, 0xffff0000, v140
    v_pk_mul_f32 v[190:191], v[190:191], v[232:233] op_sel:[0,0] op_sel_hi:[1,0]
    v_cvt_pk_bf16_f32 v140, v190, v191
    v_lshlrev_b32 v242, 16, v141
    v_and_b32 v243, 0xffff0000, v141
    v_pk_mul_f32 v[242:243], v[242:243], v[232:233] op_sel:[0,0] op_sel_hi:[1,0]
    v_cvt_pk_bf16_f32 v141, v242, v243
    v_lshlrev_b32 v244, 16, v142
    v_and_b32 v245, 0xffff0000, v142
    v_pk_mul_f32 v[244:245], v[244:245], v[232:233] op_sel:[0,1] op_sel_hi:[1,1]
    v_cvt_pk_bf16_f32 v142, v244, v245
    v_lshlrev_b32 v246, 16, v143
    v_and_b32 v247, 0xffff0000, v143
    v_pk_mul_f32 v[246:247], v[246:247], v[232:233] op_sel:[0,1] op_sel_hi:[1,1]
    v_cvt_pk_bf16_f32 v143, v246, v247
    v_lshlrev_b32 v190, 16, v144
    v_and_b32 v191, 0xffff0000, v144
    v_pk_mul_f32 v[190:191], v[190:191], v[234:235] op_sel:[0,0] op_sel_hi:[1,0]
    v_cvt_pk_bf16_f32 v144, v190, v191
    v_lshlrev_b32 v242, 16, v145
    v_and_b32 v243, 0xffff0000, v145
    v_pk_mul_f32 v[242:243], v[242:243], v[234:235] op_sel:[0,0] op_sel_hi:[1,0]
    v_cvt_pk_bf16_f32 v145, v242, v243
    v_lshlrev_b32 v244, 16, v146
    v_and_b32 v245, 0xffff0000, v146
    v_pk_mul_f32 v[244:245], v[244:245], v[234:235] op_sel:[0,1] op_sel_hi:[1,1]
    v_cvt_pk_bf16_f32 v146, v244, v245
    v_lshlrev_b32 v246, 16, v147
    v_and_b32 v247, 0xffff0000, v147
    v_pk_mul_f32 v[246:247], v[246:247], v[234:235] op_sel:[0,1] op_sel_hi:[1,1]
    v_cvt_pk_bf16_f32 v147, v246, v247
    v_lshlrev_b32 v190, 16, v148
    v_and_b32 v191, 0xffff0000, v148
    v_pk_mul_f32 v[190:191], v[190:191], v[236:237] op_sel:[0,0] op_sel_hi:[1,0]
    v_cvt_pk_bf16_f32 v148, v190, v191
    v_lshlrev_b32 v242, 16, v149
    v_and_b32 v243, 0xffff0000, v149
    v_pk_mul_f32 v[242:243], v[242:243], v[236:237] op_sel:[0,0] op_sel_hi:[1,0]
    v_cvt_pk_bf16_f32 v149, v242, v243
    v_lshlrev_b32 v244, 16, v150
    v_and_b32 v245, 0xffff0000, v150
    v_pk_mul_f32 v[244:245], v[244:245], v[236:237] op_sel:[0,1] op_sel_hi:[1,1]
    v_cvt_pk_bf16_f32 v150, v244, v245
    v_lshlrev_b32 v246, 16, v151
    v_and_b32 v247, 0xffff0000, v151
    v_pk_mul_f32 v[246:247], v[246:247], v[236:237] op_sel:[0,1] op_sel_hi:[1,1]
    v_cvt_pk_bf16_f32 v151, v246, v247
    v_lshlrev_b32 v190, 16, v152
    v_and_b32 v191, 0xffff0000, v152
    v_pk_mul_f32 v[190:191], v[190:191], v[238:239] op_sel:[0,0] op_sel_hi:[1,0]
    v_cvt_pk_bf16_f32 v152, v190, v191
    v_lshlrev_b32 v242, 16, v153
    v_and_b32 v243, 0xffff0000, v153
    v_pk_mul_f32 v[242:243], v[242:243], v[238:239] op_sel:[0,0] op_sel_hi:[1,0]
    v_cvt_pk_bf16_f32 v153, v242, v243
    v_lshlrev_b32 v244, 16, v154
    v_and_b32 v245, 0xffff0000, v154
    v_pk_mul_f32 v[244:245], v[244:245], v[238:239] op_sel:[0,1] op_sel_hi:[1,1]
    v_cvt_pk_bf16_f32 v154, v244, v245
    v_lshlrev_b32 v246, 16, v155
    v_and_b32 v247, 0xffff0000, v155
    v_pk_mul_f32 v[246:247], v[246:247], v[238:239] op_sel:[0,1] op_sel_hi:[1,1]
    v_cvt_pk_bf16_f32 v155, v246, v247
    v_lshlrev_b32 v190, 16, v156
    v_and_b32 v191, 0xffff0000, v156
    v_pk_mul_f32 v[190:191], v[190:191], v[240:241] op_sel:[0,0] op_sel_hi:[1,0]
    v_cvt_pk_bf16_f32 v156, v190, v191
    v_lshlrev_b32 v242, 16, v157
    v_and_b32 v243, 0xffff0000, v157
    v_pk_mul_f32 v[242:243], v[242:243], v[240:241] op_sel:[0,0] op_sel_hi:[1,0]
    v_cvt_pk_bf16_f32 v157, v242, v243
    v_lshlrev_b32 v244, 16, v158
    v_and_b32 v245, 0xffff0000, v158
    v_pk_mul_f32 v[244:245], v[244:245], v[240:241] op_sel:[0,1] op_sel_hi:[1,1]
    v_cvt_pk_bf16_f32 v158, v244, v245
    v_lshlrev_b32 v246, 16, v159
    v_and_b32 v247, 0xffff0000, v159
    v_pk_mul_f32 v[246:247], v[246:247], v[240:241] op_sel:[0,1] op_sel_hi:[1,1]
    v_cvt_pk_bf16_f32 v159, v246, v247
    ds_write_b128 v9, v[140:143] offset:5120
    ds_write_b128 v9, v[144:147] offset:6144
    ds_write_b128 v9, v[148:151] offset:7168
    ds_write_b128 v9, v[152:155] offset:8192
    ds_write_b128 v9, v[156:159] offset:9216
    ds_read_b128 v[140:143], v9 offset:15360
    ds_read_b128 v[144:147], v9 offset:16384
    ds_read_b128 v[148:151], v9 offset:17408
    ds_read_b128 v[152:155], v9 offset:18432
    ds_read_b128 v[156:159], v9 offset:19456
    ds_read_b32 v232, v10 offset:1536
    ds_read_b32 v233, v11 offset:1536
    ds_read_b32 v234, v12 offset:1540
    ds_read_b32 v235, v13 offset:1544
    ds_read_b32 v236, v10 offset:1548
    ds_read_b32 v237, v10 offset:1552
    ds_read_b32 v238, v11 offset:1552
    ds_read_b32 v239, v12 offset:1556
    ds_read_b32 v240, v13 offset:1560
    ds_read_b32 v241, v10 offset:1564
    s_waitcnt lgkmcnt(15)
    v_lshlrev_b32 v190, 16, v120
    v_and_b32 v191, 0xffff0000, v120
    v_pk_mul_f32 v[190:191], v[190:191], v[180:181] op_sel:[0,0] op_sel_hi:[1,0]
    v_cvt_pk_bf16_f32 v120, v190, v191
    v_lshlrev_b32 v242, 16, v121
    v_and_b32 v243, 0xffff0000, v121
    v_pk_mul_f32 v[242:243], v[242:243], v[180:181] op_sel:[0,0] op_sel_hi:[1,0]
    v_cvt_pk_bf16_f32 v121, v242, v243
    v_lshlrev_b32 v244, 16, v122
    v_and_b32 v245, 0xffff0000, v122
    v_pk_mul_f32 v[244:245], v[244:245], v[180:181] op_sel:[0,1] op_sel_hi:[1,1]
    v_cvt_pk_bf16_f32 v122, v244, v245
    v_lshlrev_b32 v246, 16, v123
    v_and_b32 v247, 0xffff0000, v123
    v_pk_mul_f32 v[246:247], v[246:247], v[180:181] op_sel:[0,1] op_sel_hi:[1,1]
    v_cvt_pk_bf16_f32 v123, v246, v247
    v_lshlrev_b32 v190, 16, v124
    v_and_b32 v191, 0xffff0000, v124
    v_pk_mul_f32 v[190:191], v[190:191], v[182:183] op_sel:[0,0] op_sel_hi:[1,0]
    v_cvt_pk_bf16_f32 v124, v190, v191
    v_lshlrev_b32 v242, 16, v125
    v_and_b32 v243, 0xffff0000, v125
    v_pk_mul_f32 v[242:243], v[242:243], v[182:183] op_sel:[0,0] op_sel_hi:[1,0]
    v_cvt_pk_bf16_f32 v125, v242, v243
    v_lshlrev_b32 v244, 16, v126
    v_and_b32 v245, 0xffff0000, v126
    v_pk_mul_f32 v[244:245], v[244:245], v[182:183] op_sel:[0,1] op_sel_hi:[1,1]
    v_cvt_pk_bf16_f32 v126, v244, v245
    v_lshlrev_b32 v246, 16, v127
    v_and_b32 v247, 0xffff0000, v127
    v_pk_mul_f32 v[246:247], v[246:247], v[182:183] op_sel:[0,1] op_sel_hi:[1,1]
    v_cvt_pk_bf16_f32 v127, v246, v247
    v_lshlrev_b32 v190, 16, v128
    v_and_b32 v191, 0xffff0000, v128
    v_pk_mul_f32 v[190:191], v[190:191], v[184:185] op_sel:[0,0] op_sel_hi:[1,0]
    v_cvt_pk_bf16_f32 v128, v190, v191
    v_lshlrev_b32 v242, 16, v129
    v_and_b32 v243, 0xffff0000, v129
    v_pk_mul_f32 v[242:243], v[242:243], v[184:185] op_sel:[0,0] op_sel_hi:[1,0]
    v_cvt_pk_bf16_f32 v129, v242, v243
    v_lshlrev_b32 v244, 16, v130
    v_and_b32 v245, 0xffff0000, v130
    v_pk_mul_f32 v[244:245], v[244:245], v[184:185] op_sel:[0,1] op_sel_hi:[1,1]
    v_cvt_pk_bf16_f32 v130, v244, v245
    v_lshlrev_b32 v246, 16, v131
    v_and_b32 v247, 0xffff0000, v131
    v_pk_mul_f32 v[246:247], v[246:247], v[184:185] op_sel:[0,1] op_sel_hi:[1,1]
    v_cvt_pk_bf16_f32 v131, v246, v247
    v_lshlrev_b32 v190, 16, v132
    v_and_b32 v191, 0xffff0000, v132
    v_pk_mul_f32 v[190:191], v[190:191], v[186:187] op_sel:[0,0] op_sel_hi:[1,0]
    v_cvt_pk_bf16_f32 v132, v190, v191
    v_lshlrev_b32 v242, 16, v133
    v_and_b32 v243, 0xffff0000, v133
    v_pk_mul_f32 v[242:243], v[242:243], v[186:187] op_sel:[0,0] op_sel_hi:[1,0]
    v_cvt_pk_bf16_f32 v133, v242, v243
    v_lshlrev_b32 v244, 16, v134
    v_and_b32 v245, 0xffff0000, v134
    v_pk_mul_f32 v[244:245], v[244:245], v[186:187] op_sel:[0,1] op_sel_hi:[1,1]
    v_cvt_pk_bf16_f32 v134, v244, v245
    v_lshlrev_b32 v246, 16, v135
    v_and_b32 v247, 0xffff0000, v135
    v_pk_mul_f32 v[246:247], v[246:247], v[186:187] op_sel:[0,1] op_sel_hi:[1,1]
    v_cvt_pk_bf16_f32 v135, v246, v247
    v_lshlrev_b32 v190, 16, v136
    v_and_b32 v191, 0xffff0000, v136
    v_pk_mul_f32 v[190:191], v[190:191], v[188:189] op_sel:[0,0] op_sel_hi:[1,0]
    v_cvt_pk_bf16_f32 v136, v190, v191
    v_lshlrev_b32 v242, 16, v137
    v_and_b32 v243, 0xffff0000, v137
    v_pk_mul_f32 v[242:243], v[242:243], v[188:189] op_sel:[0,0] op_sel_hi:[1,0]
    v_cvt_pk_bf16_f32 v137, v242, v243
    v_lshlrev_b32 v244, 16, v138
    v_and_b32 v245, 0xffff0000, v138
    v_pk_mul_f32 v[244:245], v[244:245], v[188:189] op_sel:[0,1] op_sel_hi:[1,1]
    v_cvt_pk_bf16_f32 v138, v244, v245
    v_lshlrev_b32 v246, 16, v139
    v_and_b32 v247, 0xffff0000, v139
    v_pk_mul_f32 v[246:247], v[246:247], v[188:189] op_sel:[0,1] op_sel_hi:[1,1]
    v_cvt_pk_bf16_f32 v139, v246, v247
    ds_write_b128 v9, v[120:123] offset:10240
    ds_write_b128 v9, v[124:127] offset:11264
    ds_write_b128 v9, v[128:131] offset:12288
    ds_write_b128 v9, v[132:135] offset:13312
    ds_write_b128 v9, v[136:139] offset:14336
    s_waitcnt lgkmcnt(5)
    v_lshlrev_b32 v190, 16, v140
    v_and_b32 v191, 0xffff0000, v140
    v_pk_mul_f32 v[190:191], v[190:191], v[232:233] op_sel:[0,0] op_sel_hi:[1,0]
    v_cvt_pk_bf16_f32 v140, v190, v191
    v_lshlrev_b32 v242, 16, v141
    v_and_b32 v243, 0xffff0000, v141
    v_pk_mul_f32 v[242:243], v[242:243], v[232:233] op_sel:[0,0] op_sel_hi:[1,0]
    v_cvt_pk_bf16_f32 v141, v242, v243
    v_lshlrev_b32 v244, 16, v142
    v_and_b32 v245, 0xffff0000, v142
    v_pk_mul_f32 v[244:245], v[244:245], v[232:233] op_sel:[0,1] op_sel_hi:[1,1]
    v_cvt_pk_bf16_f32 v142, v244, v245
    v_lshlrev_b32 v246, 16, v143
    v_and_b32 v247, 0xffff0000, v143
    v_pk_mul_f32 v[246:247], v[246:247], v[232:233] op_sel:[0,1] op_sel_hi:[1,1]
    v_cvt_pk_bf16_f32 v143, v246, v247
    v_lshlrev_b32 v190, 16, v144
    v_and_b32 v191, 0xffff0000, v144
    v_pk_mul_f32 v[190:191], v[190:191], v[234:235] op_sel:[0,0] op_sel_hi:[1,0]
    v_cvt_pk_bf16_f32 v144, v190, v191
    v_lshlrev_b32 v242, 16, v145
    v_and_b32 v243, 0xffff0000, v145
    v_pk_mul_f32 v[242:243], v[242:243], v[234:235] op_sel:[0,0] op_sel_hi:[1,0]
    v_cvt_pk_bf16_f32 v145, v242, v243
    v_lshlrev_b32 v244, 16, v146
    v_and_b32 v245, 0xffff0000, v146
    v_pk_mul_f32 v[244:245], v[244:245], v[234:235] op_sel:[0,1] op_sel_hi:[1,1]
    v_cvt_pk_bf16_f32 v146, v244, v245
    v_lshlrev_b32 v246, 16, v147
    v_and_b32 v247, 0xffff0000, v147
    v_pk_mul_f32 v[246:247], v[246:247], v[234:235] op_sel:[0,1] op_sel_hi:[1,1]
    v_cvt_pk_bf16_f32 v147, v246, v247
    v_lshlrev_b32 v190, 16, v148
    v_and_b32 v191, 0xffff0000, v148
    v_pk_mul_f32 v[190:191], v[190:191], v[236:237] op_sel:[0,0] op_sel_hi:[1,0]
    v_cvt_pk_bf16_f32 v148, v190, v191
    v_lshlrev_b32 v242, 16, v149
    v_and_b32 v243, 0xffff0000, v149
    v_pk_mul_f32 v[242:243], v[242:243], v[236:237] op_sel:[0,0] op_sel_hi:[1,0]
    v_cvt_pk_bf16_f32 v149, v242, v243
    v_lshlrev_b32 v244, 16, v150
    v_and_b32 v245, 0xffff0000, v150
    v_pk_mul_f32 v[244:245], v[244:245], v[236:237] op_sel:[0,1] op_sel_hi:[1,1]
    v_cvt_pk_bf16_f32 v150, v244, v245
    v_lshlrev_b32 v246, 16, v151
    v_and_b32 v247, 0xffff0000, v151
    v_pk_mul_f32 v[246:247], v[246:247], v[236:237] op_sel:[0,1] op_sel_hi:[1,1]
    v_cvt_pk_bf16_f32 v151, v246, v247
    v_lshlrev_b32 v190, 16, v152
    v_and_b32 v191, 0xffff0000, v152
    v_pk_mul_f32 v[190:191], v[190:191], v[238:239] op_sel:[0,0] op_sel_hi:[1,0]
    v_cvt_pk_bf16_f32 v152, v190, v191
    v_lshlrev_b32 v242, 16, v153
    v_and_b32 v243, 0xffff0000, v153
    v_pk_mul_f32 v[242:243], v[242:243], v[238:239] op_sel:[0,0] op_sel_hi:[1,0]
    v_cvt_pk_bf16_f32 v153, v242, v243
    v_lshlrev_b32 v244, 16, v154
    v_and_b32 v245, 0xffff0000, v154
    v_pk_mul_f32 v[244:245], v[244:245], v[238:239] op_sel:[0,1] op_sel_hi:[1,1]
    v_cvt_pk_bf16_f32 v154, v244, v245
    v_lshlrev_b32 v246, 16, v155
    v_and_b32 v247, 0xffff0000, v155
    v_pk_mul_f32 v[246:247], v[246:247], v[238:239] op_sel:[0,1] op_sel_hi:[1,1]
    v_cvt_pk_bf16_f32 v155, v246, v247
    v_lshlrev_b32 v190, 16, v156
    v_and_b32 v191, 0xffff0000, v156
    v_pk_mul_f32 v[190:191], v[190:191], v[240:241] op_sel:[0,0] op_sel_hi:[1,0]
    v_cvt_pk_bf16_f32 v156, v190, v191
    v_lshlrev_b32 v242, 16, v157
    v_and_b32 v243, 0xffff0000, v157
    v_pk_mul_f32 v[242:243], v[242:243], v[240:241] op_sel:[0,0] op_sel_hi:[1,0]
    v_cvt_pk_bf16_f32 v157, v242, v243
    v_lshlrev_b32 v244, 16, v158
    v_and_b32 v245, 0xffff0000, v158
    v_pk_mul_f32 v[244:245], v[244:245], v[240:241] op_sel:[0,1] op_sel_hi:[1,1]
    v_cvt_pk_bf16_f32 v158, v244, v245
    v_lshlrev_b32 v246, 16, v159
    v_and_b32 v247, 0xffff0000, v159
    v_pk_mul_f32 v[246:247], v[246:247], v[240:241] op_sel:[0,1] op_sel_hi:[1,1]
    v_cvt_pk_bf16_f32 v159, v246, v247
    ds_write_b128 v9, v[140:143] offset:15360
    ds_write_b128 v9, v[144:147] offset:16384
    ds_write_b128 v9, v[148:151] offset:17408
    ds_write_b128 v9, v[152:155] offset:18432
    ds_write_b128 v9, v[156:159] offset:19456
    s_waitcnt vmcnt(10)
    s_waitcnt lgkmcnt(0)
    v_cvt_pk_bf16_f32 v120, v16, v17
    v_cvt_pk_bf16_f32 v121, v18, v19
    v_cvt_pk_bf16_f32 v122, v20, v21
    v_cvt_pk_bf16_f32 v123, v22, v23
    v_cvt_pk_bf16_f32 v124, v24, v25
    v_cvt_pk_bf16_f32 v125, v26, v27
    v_cvt_pk_bf16_f32 v126, v28, v29
    v_cvt_pk_bf16_f32 v127, v30, v31
    v_cvt_pk_bf16_f32 v128, v32, v33
    v_cvt_pk_bf16_f32 v129, v34, v35
    v_mov_b32 v130, 0
    v_mov_b32 v131, 0
    v_mov_b32 v132, 0
    v_mov_b32 v133, 0
    v_cvt_pk_bf16_f32 v134, v36, v37
    v_cvt_pk_bf16_f32 v135, v38, v39
    v_cvt_pk_bf16_f32 v136, v40, v41
    v_cvt_pk_bf16_f32 v137, v42, v43
    v_cvt_pk_bf16_f32 v138, v44, v45
    v_cvt_pk_bf16_f32 v139, v46, v47
    v_cvt_pk_bf16_f32 v140, v48, v49
    v_cvt_pk_bf16_f32 v141, v50, v51
    v_cvt_pk_bf16_f32 v142, v52, v53
    v_cvt_pk_bf16_f32 v143, v54, v55
    v_cvt_pk_bf16_f32 v144, v56, v57
    v_cvt_pk_bf16_f32 v145, v58, v59
    v_mov_b32 v146, 0
    v_mov_b32 v147, 0
    v_mov_b32 v148, 0
    v_mov_b32 v149, 0
    v_cvt_pk_bf16_f32 v150, v60, v61
    v_cvt_pk_bf16_f32 v151, v62, v63
    v_cvt_pk_bf16_f32 v152, v64, v65
    v_cvt_pk_bf16_f32 v153, v66, v67
    v_mov_b32 v154, 0
    v_mov_b32 v155, 0
    v_mov_b32 v156, 0
    v_mov_b32 v157, 0
    v_cvt_pk_bf16_f32 v158, v68, v69
    v_cvt_pk_bf16_f32 v159, v70, v71
    v_cvt_pk_bf16_f32 v160, v72, v73
    v_cvt_pk_bf16_f32 v161, v74, v75
    v_mov_b32 v162, 0
    v_mov_b32 v163, 0
    v_mov_b32 v164, 0
    v_mov_b32 v165, 0
    v_cvt_pk_bf16_f32 v166, v76, v77
    v_cvt_pk_bf16_f32 v167, v78, v79
    v_cvt_pk_bf16_f32 v168, v80, v81
    v_cvt_pk_bf16_f32 v169, v82, v83
    v_cvt_pk_bf16_f32 v170, v84, v85
    v_cvt_pk_bf16_f32 v171, v86, v87
    v_cvt_pk_bf16_f32 v172, v88, v89
    v_cvt_pk_bf16_f32 v173, v90, v91
    v_cvt_pk_bf16_f32 v174, v92, v93
    v_cvt_pk_bf16_f32 v175, v94, v95
    v_cvt_pk_bf16_f32 v176, v96, v97
    v_cvt_pk_bf16_f32 v177, v98, v99
    v_mov_b32 v178, 0
    v_mov_b32 v179, 0
    v_mov_b32 v180, 0
    v_mov_b32 v181, 0
    v_cvt_pk_bf16_f32 v182, v100, v101
    v_cvt_pk_bf16_f32 v183, v102, v103
    v_cvt_pk_bf16_f32 v184, v104, v105
    v_cvt_pk_bf16_f32 v185, v106, v107
    v_cvt_pk_bf16_f32 v186, v108, v109
    v_cvt_pk_bf16_f32 v187, v110, v111
    v_cvt_pk_bf16_f32 v188, v112, v113
    v_cvt_pk_bf16_f32 v189, v114, v115
    v_cvt_pk_bf16_f32 v190, v116, v117
    v_cvt_pk_bf16_f32 v191, v118, v119
    s_nop 1
    s_waitcnt vmcnt(5)
    v_mfma_f32_16x16x32_bf16 v[232:235], v[120:123], v[192:195], 0
    v_mfma_f32_16x16x32_bf16 v[236:239], v[124:127], v[192:195], 0
    v_mfma_f32_16x16x32_bf16 v[236:239], v[128:131], v[196:199], v[236:239]
    v_mfma_f32_16x16x32_bf16 v[240:243], v[132:135], v[192:195], 0
    v_mfma_f32_16x16x32_bf16 v[240:243], v[136:139], v[196:199], v[240:243]
    v_mfma_f32_16x16x32_bf16 v[244:247], v[140:143], v[196:199], 0
    v_mfma_f32_16x16x32_bf16 v[244:247], v[144:147], v[200:203], v[244:247]
    v_mfma_f32_16x16x32_bf16 v[248:251], v[148:151], v[196:199], 0
    v_mfma_f32_16x16x32_bf16 v[248:251], v[152:155], v[200:203], v[248:251]
    v_mfma_f32_16x16x32_bf16 v[252:255], v[156:159], v[200:203], 0
    v_mfma_f32_16x16x32_bf16 v[252:255], v[160:163], v[204:207], v[252:255]
    s_nop 1
    v_cvt_pk_bf16_f32 v16, v232, v233
    v_cvt_pk_bf16_f32 v17, v234, v235
    v_cvt_pk_bf16_f32 v18, v236, v237
    v_cvt_pk_bf16_f32 v19, v238, v239
    v_mfma_f32_16x16x32_bf16 v[232:235], v[164:167], v[200:203], 0
    v_mfma_f32_16x16x32_bf16 v[232:235], v[168:171], v[204:207], v[232:235]
    v_mfma_f32_16x16x32_bf16 v[236:239], v[172:175], v[204:207], 0
    v_mfma_f32_16x16x32_bf16 v[236:239], v[176:179], v[208:211], v[236:239]
    s_nop 1
    v_cvt_pk_bf16_f32 v36, v240, v241
    v_cvt_pk_bf16_f32 v37, v242, v243
    v_cvt_pk_bf16_f32 v38, v244, v245
    v_cvt_pk_bf16_f32 v39, v246, v247
    v_mfma_f32_16x16x32_bf16 v[240:243], v[180:183], v[204:207], 0
    v_mfma_f32_16x16x32_bf16 v[240:243], v[184:187], v[208:211], v[240:243]
    v_mfma_f32_16x16x32_bf16 v[244:247], v[188:191], v[208:211], 0
    s_nop 1
    v_cvt_pk_bf16_f32 v56, v248, v249
    v_cvt_pk_bf16_f32 v57, v250, v251
    v_cvt_pk_bf16_f32 v58, v252, v253
    v_cvt_pk_bf16_f32 v59, v254, v255
    s_add_u32 s51, s50, 40960
    buffer_load_dwordx4 v[192:195], v2, s[36:39], s51 offen offset:0
    buffer_load_dwordx4 v[196:199], v2, s[36:39], s51 offen offset:1024
    buffer_load_dwordx4 v[200:203], v2, s[36:39], s51 offen offset:2048
    buffer_load_dwordx4 v[204:207], v2, s[36:39], s51 offen offset:3072
    s_add_u32 s51, s51, 4096
    buffer_load_dwordx4 v[208:211], v2, s[36:39], s51 offen
    s_waitcnt vmcnt(5)
    v_mfma_f32_16x16x32_bf16 v[248:251], v[120:123], v[212:215], 0
    v_mfma_f32_16x16x32_bf16 v[252:255], v[124:127], v[212:215], 0
    v_mfma_f32_16x16x32_bf16 v[252:255], v[128:131], v[216:219], v[252:255]
    s_nop 1
    v_cvt_pk_bf16_f32 v76, v232, v233
    v_cvt_pk_bf16_f32 v77, v234, v235
    v_cvt_pk_bf16_f32 v78, v236, v237
    v_cvt_pk_bf16_f32 v79, v238, v239
    v_mfma_f32_16x16x32_bf16 v[232:235], v[132:135], v[212:215], 0
    v_mfma_f32_16x16x32_bf16 v[232:235], v[136:139], v[216:219], v[232:235]
    v_mfma_f32_16x16x32_bf16 v[236:239], v[140:143], v[216:219], 0
    v_mfma_f32_16x16x32_bf16 v[236:239], v[144:147], v[220:223], v[236:239]
    s_nop 1
    v_cvt_pk_bf16_f32 v96, v240, v241
    v_cvt_pk_bf16_f32 v97, v242, v243
    v_cvt_pk_bf16_f32 v98, v244, v245
    v_cvt_pk_bf16_f32 v99, v246, v247
    v_mfma_f32_16x16x32_bf16 v[240:243], v[148:151], v[216:219], 0
    v_mfma_f32_16x16x32_bf16 v[240:243], v[152:155], v[220:223], v[240:243]
    v_mfma_f32_16x16x32_bf16 v[244:247], v[156:159], v[220:223], 0
    v_mfma_f32_16x16x32_bf16 v[244:247], v[160:163], v[224:227], v[244:247]
    s_nop 1
    v_cvt_pk_bf16_f32 v20, v248, v249
    v_cvt_pk_bf16_f32 v21, v250, v251
    v_cvt_pk_bf16_f32 v22, v252, v253
    v_cvt_pk_bf16_f32 v23, v254, v255
    v_mfma_f32_16x16x32_bf16 v[248:251], v[164:167], v[220:223], 0
    v_mfma_f32_16x16x32_bf16 v[248:251], v[168:171], v[224:227], v[248:251]
    v_mfma_f32_16x16x32_bf16 v[252:255], v[172:175], v[224:227], 0
    v_mfma_f32_16x16x32_bf16 v[252:255], v[176:179], v[228:231], v[252:255]
    s_nop 1
    v_cvt_pk_bf16_f32 v40, v232, v233
    v_cvt_pk_bf16_f32 v41, v234, v235
    v_cvt_pk_bf16_f32 v42, v236, v237
    v_cvt_pk_bf16_f32 v43, v238, v239
    v_mfma_f32_16x16x32_bf16 v[232:235], v[180:183], v[224:227], 0
    v_mfma_f32_16x16x32_bf16 v[232:235], v[184:187], v[228:231], v[232:235]
    v_mfma_f32_16x16x32_bf16 v[236:239], v[188:191], v[228:231], 0
    s_nop 1
    v_cvt_pk_bf16_f32 v60, v240, v241
    v_cvt_pk_bf16_f32 v61, v242, v243
    v_cvt_pk_bf16_f32 v62, v244, v245
    v_cvt_pk_bf16_f32 v63, v246, v247
    s_add_u32 s51, s50, 61440
    buffer_load_dwordx4 v[212:215], v2, s[36:39], s51 offen offset:0
    buffer_load_dwordx4 v[216:219], v2, s[36:39], s51 offen offset:1024
    buffer_load_dwordx4 v[220:223], v2, s[36:39], s51 offen offset:2048
    buffer_load_dwordx4 v[224:227], v2, s[36:39], s51 offen offset:3072
    s_add_u32 s51, s51, 4096
    buffer_load_dwordx4 v[228:231], v2, s[36:39], s51 offen
    s_waitcnt vmcnt(5)
    v_mfma_f32_16x16x32_bf16 v[240:243], v[120:123], v[192:195], 0
    v_mfma_f32_16x16x32_bf16 v[244:247], v[124:127], v[192:195], 0
    v_mfma_f32_16x16x32_bf16 v[244:247], v[128:131], v[196:199], v[244:247]
    s_nop 1
    v_cvt_pk_bf16_f32 v80, v248, v249
    v_cvt_pk_bf16_f32 v81, v250, v251
    v_cvt_pk_bf16_f32 v82, v252, v253
    v_cvt_pk_bf16_f32 v83, v254, v255
    v_mfma_f32_16x16x32_bf16 v[248:251], v[132:135], v[192:195], 0
    v_mfma_f32_16x16x32_bf16 v[248:251], v[136:139], v[196:199], v[248:251]
    v_mfma_f32_16x16x32_bf16 v[252:255], v[140:143], v[196:199], 0
    v_mfma_f32_16x16x32_bf16 v[252:255], v[144:147], v[200:203], v[252:255]
    s_nop 1
    v_cvt_pk_bf16_f32 v100, v232, v233
    v_cvt_pk_bf16_f32 v101, v234, v235
    v_cvt_pk_bf16_f32 v102, v236, v237
    v_cvt_pk_bf16_f32 v103, v238, v239
    v_mfma_f32_16x16x32_bf16 v[232:235], v[148:151], v[196:199], 0
    v_mfma_f32_16x16x32_bf16 v[232:235], v[152:155], v[200:203], v[232:235]
    v_mfma_f32_16x16x32_bf16 v[236:239], v[156:159], v[200:203], 0
    v_mfma_f32_16x16x32_bf16 v[236:239], v[160:163], v[204:207], v[236:239]
    s_nop 1
    v_cvt_pk_bf16_f32 v24, v240, v241
    v_cvt_pk_bf16_f32 v25, v242, v243
    v_cvt_pk_bf16_f32 v26, v244, v245
    v_cvt_pk_bf16_f32 v27, v246, v247
    v_mfma_f32_16x16x32_bf16 v[240:243], v[164:167], v[200:203], 0
    v_mfma_f32_16x16x32_bf16 v[240:243], v[168:171], v[204:207], v[240:243]
    v_mfma_f32_16x16x32_bf16 v[244:247], v[172:175], v[204:207], 0
    v_mfma_f32_16x16x32_bf16 v[244:247], v[176:179], v[208:211], v[244:247]
    s_nop 1
    v_cvt_pk_bf16_f32 v44, v248, v249
    v_cvt_pk_bf16_f32 v45, v250, v251
    v_cvt_pk_bf16_f32 v46, v252, v253
    v_cvt_pk_bf16_f32 v47, v254, v255
    v_mfma_f32_16x16x32_bf16 v[248:251], v[180:183], v[204:207], 0
    v_mfma_f32_16x16x32_bf16 v[248:251], v[184:187], v[208:211], v[248:251]
    v_mfma_f32_16x16x32_bf16 v[252:255], v[188:191], v[208:211], 0
    s_nop 1
    v_cvt_pk_bf16_f32 v64, v232, v233
    v_cvt_pk_bf16_f32 v65, v234, v235
    v_cvt_pk_bf16_f32 v66, v236, v237
    v_cvt_pk_bf16_f32 v67, v238, v239
    s_add_u32 s51, s50, 81920
    buffer_load_dwordx4 v[192:195], v2, s[36:39], s51 offen offset:0
    buffer_load_dwordx4 v[196:199], v2, s[36:39], s51 offen offset:1024
    buffer_load_dwordx4 v[200:203], v2, s[36:39], s51 offen offset:2048
    buffer_load_dwordx4 v[204:207], v2, s[36:39], s51 offen offset:3072
    s_add_u32 s51, s51, 4096
    buffer_load_dwordx4 v[208:211], v2, s[36:39], s51 offen
    s_waitcnt vmcnt(5)
    v_mfma_f32_16x16x32_bf16 v[232:235], v[120:123], v[212:215], 0
    v_mfma_f32_16x16x32_bf16 v[236:239], v[124:127], v[212:215], 0
    v_mfma_f32_16x16x32_bf16 v[236:239], v[128:131], v[216:219], v[236:239]
    s_nop 1
    v_cvt_pk_bf16_f32 v84, v240, v241
    v_cvt_pk_bf16_f32 v85, v242, v243
    v_cvt_pk_bf16_f32 v86, v244, v245
    v_cvt_pk_bf16_f32 v87, v246, v247
    v_mfma_f32_16x16x32_bf16 v[240:243], v[132:135], v[212:215], 0
    v_mfma_f32_16x16x32_bf16 v[240:243], v[136:139], v[216:219], v[240:243]
    v_mfma_f32_16x16x32_bf16 v[244:247], v[140:143], v[216:219], 0
    v_mfma_f32_16x16x32_bf16 v[244:247], v[144:147], v[220:223], v[244:247]
    s_nop 1
    v_cvt_pk_bf16_f32 v104, v248, v249
    v_cvt_pk_bf16_f32 v105, v250, v251
    v_cvt_pk_bf16_f32 v106, v252, v253
    v_cvt_pk_bf16_f32 v107, v254, v255
    v_mfma_f32_16x16x32_bf16 v[248:251], v[148:151], v[216:219], 0
    v_mfma_f32_16x16x32_bf16 v[248:251], v[152:155], v[220:223], v[248:251]
    v_mfma_f32_16x16x32_bf16 v[252:255], v[156:159], v[220:223], 0
    v_mfma_f32_16x16x32_bf16 v[252:255], v[160:163], v[224:227], v[252:255]
    s_nop 1
    v_cvt_pk_bf16_f32 v28, v232, v233
    v_cvt_pk_bf16_f32 v29, v234, v235
    v_cvt_pk_bf16_f32 v30, v236, v237
    v_cvt_pk_bf16_f32 v31, v238, v239
    v_mfma_f32_16x16x32_bf16 v[232:235], v[164:167], v[220:223], 0
    v_mfma_f32_16x16x32_bf16 v[232:235], v[168:171], v[224:227], v[232:235]
    v_mfma_f32_16x16x32_bf16 v[236:239], v[172:175], v[224:227], 0
    v_mfma_f32_16x16x32_bf16 v[236:239], v[176:179], v[228:231], v[236:239]
    s_nop 1
    v_cvt_pk_bf16_f32 v48, v240, v241
    v_cvt_pk_bf16_f32 v49, v242, v243
    v_cvt_pk_bf16_f32 v50, v244, v245
    v_cvt_pk_bf16_f32 v51, v246, v247
    v_mfma_f32_16x16x32_bf16 v[240:243], v[180:183], v[224:227], 0
    v_mfma_f32_16x16x32_bf16 v[240:243], v[184:187], v[228:231], v[240:243]
    v_mfma_f32_16x16x32_bf16 v[244:247], v[188:191], v[228:231], 0
    s_nop 1
    v_cvt_pk_bf16_f32 v68, v248, v249
    v_cvt_pk_bf16_f32 v69, v250, v251
    v_cvt_pk_bf16_f32 v70, v252, v253
    v_cvt_pk_bf16_f32 v71, v254, v255
    s_waitcnt vmcnt(0)
    v_mfma_f32_16x16x32_bf16 v[248:251], v[120:123], v[192:195], 0
    v_mfma_f32_16x16x32_bf16 v[252:255], v[124:127], v[192:195], 0
    v_mfma_f32_16x16x32_bf16 v[252:255], v[128:131], v[196:199], v[252:255]
    s_nop 1
    v_cvt_pk_bf16_f32 v88, v232, v233
    v_cvt_pk_bf16_f32 v89, v234, v235
    v_cvt_pk_bf16_f32 v90, v236, v237
    v_cvt_pk_bf16_f32 v91, v238, v239
    v_mfma_f32_16x16x32_bf16 v[232:235], v[132:135], v[192:195], 0
    v_mfma_f32_16x16x32_bf16 v[232:235], v[136:139], v[196:199], v[232:235]
    v_mfma_f32_16x16x32_bf16 v[236:239], v[140:143], v[196:199], 0
    v_mfma_f32_16x16x32_bf16 v[236:239], v[144:147], v[200:203], v[236:239]
    s_nop 1
    v_cvt_pk_bf16_f32 v108, v240, v241
    v_cvt_pk_bf16_f32 v109, v242, v243
    v_cvt_pk_bf16_f32 v110, v244, v245
    v_cvt_pk_bf16_f32 v111, v246, v247
    v_mfma_f32_16x16x32_bf16 v[240:243], v[148:151], v[196:199], 0
    v_mfma_f32_16x16x32_bf16 v[240:243], v[152:155], v[200:203], v[240:243]
    v_mfma_f32_16x16x32_bf16 v[244:247], v[156:159], v[200:203], 0
    v_mfma_f32_16x16x32_bf16 v[244:247], v[160:163], v[204:207], v[244:247]
    s_nop 1
    v_cvt_pk_bf16_f32 v32, v248, v249
    v_cvt_pk_bf16_f32 v33, v250, v251
    v_cvt_pk_bf16_f32 v34, v252, v253
    v_cvt_pk_bf16_f32 v35, v254, v255
    v_mfma_f32_16x16x32_bf16 v[248:251], v[164:167], v[200:203], 0
    v_mfma_f32_16x16x32_bf16 v[248:251], v[168:171], v[204:207], v[248:251]
    v_mfma_f32_16x16x32_bf16 v[252:255], v[172:175], v[204:207], 0
    v_mfma_f32_16x16x32_bf16 v[252:255], v[176:179], v[208:211], v[252:255]
    s_nop 1
    v_cvt_pk_bf16_f32 v52, v232, v233
    v_cvt_pk_bf16_f32 v53, v234, v235
    v_cvt_pk_bf16_f32 v54, v236, v237
    v_cvt_pk_bf16_f32 v55, v238, v239
    v_mfma_f32_16x16x32_bf16 v[232:235], v[180:183], v[204:207], 0
    v_mfma_f32_16x16x32_bf16 v[232:235], v[184:187], v[208:211], v[232:235]
    v_mfma_f32_16x16x32_bf16 v[236:239], v[188:191], v[208:211], 0
    s_nop 1
    v_cvt_pk_bf16_f32 v72, v240, v241
    v_cvt_pk_bf16_f32 v73, v242, v243
    v_cvt_pk_bf16_f32 v74, v244, v245
    v_cvt_pk_bf16_f32 v75, v246, v247
    ds_read_b128 v[200:203], v9 offset:0
    ds_read_b128 v[204:207], v9 offset:1024
    ds_read_b128 v[208:211], v9 offset:2048
    ds_read_b128 v[212:215], v9 offset:3072
    ds_read_b128 v[216:219], v9 offset:4096
    s_nop 7
    v_cvt_pk_bf16_f32 v92, v248, v249
    v_cvt_pk_bf16_f32 v93, v250, v251
    v_cvt_pk_bf16_f32 v94, v252, v253
    v_cvt_pk_bf16_f32 v95, v254, v255
    v_cvt_pk_bf16_f32 v112, v232, v233
    v_cvt_pk_bf16_f32 v113, v234, v235
    v_cvt_pk_bf16_f32 v114, v236, v237
    v_cvt_pk_bf16_f32 v115, v238, v239
    ds_read_b128 v[220:223], v9 offset:5120
    ds_read_b128 v[224:227], v9 offset:6144
    ds_read_b128 v[228:231], v9 offset:7168
    ds_read_b128 v[232:235], v9 offset:8192
    ds_read_b128 v[236:239], v9 offset:9216
    s_waitcnt lgkmcnt(5)
    v_mfma_f32_16x16x32_bf16 v[120:123], v[16:19], v[200:203], 0
    v_mfma_f32_16x16x32_bf16 v[124:127], v[20:23], v[200:203], 0
    v_mfma_f32_16x16x32_bf16 v[128:131], v[24:27], v[200:203], 0
    v_mfma_f32_16x16x32_bf16 v[132:135], v[28:31], v[200:203], 0
    v_mfma_f32_16x16x32_bf16 v[136:139], v[32:35], v[200:203], 0
    v_mfma_f32_16x16x32_bf16 v[120:123], v[36:39], v[204:207], v[120:123]
    v_mfma_f32_16x16x32_bf16 v[124:127], v[40:43], v[204:207], v[124:127]
    v_mfma_f32_16x16x32_bf16 v[128:131], v[44:47], v[204:207], v[128:131]
    v_mfma_f32_16x16x32_bf16 v[132:135], v[48:51], v[204:207], v[132:135]
    v_mfma_f32_16x16x32_bf16 v[136:139], v[52:55], v[204:207], v[136:139]
    v_mfma_f32_16x16x32_bf16 v[120:123], v[56:59], v[208:211], v[120:123]
    v_mfma_f32_16x16x32_bf16 v[124:127], v[60:63], v[208:211], v[124:127]
    v_mfma_f32_16x16x32_bf16 v[128:131], v[64:67], v[208:211], v[128:131]
    v_mfma_f32_16x16x32_bf16 v[132:135], v[68:71], v[208:211], v[132:135]
    v_mfma_f32_16x16x32_bf16 v[136:139], v[72:75], v[208:211], v[136:139]
    v_mfma_f32_16x16x32_bf16 v[120:123], v[76:79], v[212:215], v[120:123]
    v_mfma_f32_16x16x32_bf16 v[124:127], v[80:83], v[212:215], v[124:127]
    v_mfma_f32_16x16x32_bf16 v[128:131], v[84:87], v[212:215], v[128:131]
    v_mfma_f32_16x16x32_bf16 v[132:135], v[88:91], v[212:215], v[132:135]
    v_mfma_f32_16x16x32_bf16 v[136:139], v[92:95], v[212:215], v[136:139]
    v_mfma_f32_16x16x32_bf16 v[120:123], v[96:99], v[216:219], v[120:123]
    v_mfma_f32_16x16x32_bf16 v[124:127], v[100:103], v[216:219], v[124:127]
    v_mfma_f32_16x16x32_bf16 v[128:131], v[104:107], v[216:219], v[128:131]
    v_mfma_f32_16x16x32_bf16 v[132:135], v[108:111], v[216:219], v[132:135]
    v_mfma_f32_16x16x32_bf16 v[136:139], v[112:115], v[216:219], v[136:139]
    ds_read_b128 v[200:203], v9 offset:10240
    ds_read_b128 v[204:207], v9 offset:11264
    ds_read_b128 v[208:211], v9 offset:12288
    ds_read_b128 v[212:215], v9 offset:13312
    ds_read_b128 v[216:219], v9 offset:14336
    s_waitcnt lgkmcnt(5)
    v_mfma_f32_16x16x32_bf16 v[140:143], v[16:19], v[220:223], 0
    v_mfma_f32_16x16x32_bf16 v[144:147], v[20:23], v[220:223], 0
    v_mfma_f32_16x16x32_bf16 v[148:151], v[24:27], v[220:223], 0
    v_mfma_f32_16x16x32_bf16 v[152:155], v[28:31], v[220:223], 0
    v_mfma_f32_16x16x32_bf16 v[156:159], v[32:35], v[220:223], 0
    v_mfma_f32_16x16x32_bf16 v[140:143], v[36:39], v[224:227], v[140:143]
    v_mfma_f32_16x16x32_bf16 v[144:147], v[40:43], v[224:227], v[144:147]
    v_mfma_f32_16x16x32_bf16 v[148:151], v[44:47], v[224:227], v[148:151]
    v_mfma_f32_16x16x32_bf16 v[152:155], v[48:51], v[224:227], v[152:155]
    v_mfma_f32_16x16x32_bf16 v[156:159], v[52:55], v[224:227], v[156:159]
    v_mfma_f32_16x16x32_bf16 v[140:143], v[56:59], v[228:231], v[140:143]
    v_mfma_f32_16x16x32_bf16 v[144:147], v[60:63], v[228:231], v[144:147]
    v_mfma_f32_16x16x32_bf16 v[148:151], v[64:67], v[228:231], v[148:151]
    v_mfma_f32_16x16x32_bf16 v[152:155], v[68:71], v[228:231], v[152:155]
    v_mfma_f32_16x16x32_bf16 v[156:159], v[72:75], v[228:231], v[156:159]
    v_mfma_f32_16x16x32_bf16 v[140:143], v[76:79], v[232:235], v[140:143]
    v_mfma_f32_16x16x32_bf16 v[144:147], v[80:83], v[232:235], v[144:147]
    v_mfma_f32_16x16x32_bf16 v[148:151], v[84:87], v[232:235], v[148:151]
    v_mfma_f32_16x16x32_bf16 v[152:155], v[88:91], v[232:235], v[152:155]
    v_mfma_f32_16x16x32_bf16 v[156:159], v[92:95], v[232:235], v[156:159]
    v_mfma_f32_16x16x32_bf16 v[140:143], v[96:99], v[236:239], v[140:143]
    v_mfma_f32_16x16x32_bf16 v[144:147], v[100:103], v[236:239], v[144:147]
    v_mfma_f32_16x16x32_bf16 v[148:151], v[104:107], v[236:239], v[148:151]
    v_mfma_f32_16x16x32_bf16 v[152:155], v[108:111], v[236:239], v[152:155]
    v_mfma_f32_16x16x32_bf16 v[156:159], v[112:115], v[236:239], v[156:159]
    ds_write_b128 v9, v[120:123] offset:0
    ds_write_b128 v9, v[124:127] offset:1024
    ds_write_b128 v9, v[128:131] offset:2048
    ds_write_b128 v9, v[132:135] offset:3072
    ds_write_b128 v9, v[136:139] offset:4096
    ds_read_b128 v[220:223], v9 offset:15360
    ds_read_b128 v[224:227], v9 offset:16384
    ds_read_b128 v[228:231], v9 offset:17408
    ds_read_b128 v[232:235], v9 offset:18432
    ds_read_b128 v[236:239], v9 offset:19456
    s_waitcnt lgkmcnt(5)
    v_mfma_f32_16x16x32_bf16 v[160:163], v[16:19], v[200:203], 0
    v_mfma_f32_16x16x32_bf16 v[164:167], v[20:23], v[200:203], 0
    v_mfma_f32_16x16x32_bf16 v[168:171], v[24:27], v[200:203], 0
    v_mfma_f32_16x16x32_bf16 v[172:175], v[28:31], v[200:203], 0
    v_mfma_f32_16x16x32_bf16 v[176:179], v[32:35], v[200:203], 0
    v_mfma_f32_16x16x32_bf16 v[160:163], v[36:39], v[204:207], v[160:163]
    v_mfma_f32_16x16x32_bf16 v[164:167], v[40:43], v[204:207], v[164:167]
    v_mfma_f32_16x16x32_bf16 v[168:171], v[44:47], v[204:207], v[168:171]
    v_mfma_f32_16x16x32_bf16 v[172:175], v[48:51], v[204:207], v[172:175]
    v_mfma_f32_16x16x32_bf16 v[176:179], v[52:55], v[204:207], v[176:179]
    v_mfma_f32_16x16x32_bf16 v[160:163], v[56:59], v[208:211], v[160:163]
    v_mfma_f32_16x16x32_bf16 v[164:167], v[60:63], v[208:211], v[164:167]
    v_mfma_f32_16x16x32_bf16 v[168:171], v[64:67], v[208:211], v[168:171]
    v_mfma_f32_16x16x32_bf16 v[172:175], v[68:71], v[208:211], v[172:175]
    v_mfma_f32_16x16x32_bf16 v[176:179], v[72:75], v[208:211], v[176:179]
    v_mfma_f32_16x16x32_bf16 v[160:163], v[76:79], v[212:215], v[160:163]
    v_mfma_f32_16x16x32_bf16 v[164:167], v[80:83], v[212:215], v[164:167]
    v_mfma_f32_16x16x32_bf16 v[168:171], v[84:87], v[212:215], v[168:171]
    v_mfma_f32_16x16x32_bf16 v[172:175], v[88:91], v[212:215], v[172:175]
    v_mfma_f32_16x16x32_bf16 v[176:179], v[92:95], v[212:215], v[176:179]
    v_mfma_f32_16x16x32_bf16 v[160:163], v[96:99], v[216:219], v[160:163]
    v_mfma_f32_16x16x32_bf16 v[164:167], v[100:103], v[216:219], v[164:167]
    v_mfma_f32_16x16x32_bf16 v[168:171], v[104:107], v[216:219], v[168:171]
    v_mfma_f32_16x16x32_bf16 v[172:175], v[108:111], v[216:219], v[172:175]
    v_mfma_f32_16x16x32_bf16 v[176:179], v[112:115], v[216:219], v[176:179]
    ds_write_b128 v9, v[140:143] offset:5120
    ds_write_b128 v9, v[144:147] offset:6144
    ds_write_b128 v9, v[148:151] offset:7168
    ds_write_b128 v9, v[152:155] offset:8192
    ds_write_b128 v9, v[156:159] offset:9216
    s_waitcnt lgkmcnt(0)
    v_mfma_f32_16x16x32_bf16 v[180:183], v[16:19], v[220:223], 0
    v_mfma_f32_16x16x32_bf16 v[184:187], v[20:23], v[220:223], 0
    v_mfma_f32_16x16x32_bf16 v[188:191], v[24:27], v[220:223], 0
    v_mfma_f32_16x16x32_bf16 v[192:195], v[28:31], v[220:223], 0
    v_mfma_f32_16x16x32_bf16 v[196:199], v[32:35], v[220:223], 0
    v_mfma_f32_16x16x32_bf16 v[180:183], v[36:39], v[224:227], v[180:183]
    v_mfma_f32_16x16x32_bf16 v[184:187], v[40:43], v[224:227], v[184:187]
    v_mfma_f32_16x16x32_bf16 v[188:191], v[44:47], v[224:227], v[188:191]
    v_mfma_f32_16x16x32_bf16 v[192:195], v[48:51], v[224:227], v[192:195]
    v_mfma_f32_16x16x32_bf16 v[196:199], v[52:55], v[224:227], v[196:199]
    v_mfma_f32_16x16x32_bf16 v[180:183], v[56:59], v[228:231], v[180:183]
    v_mfma_f32_16x16x32_bf16 v[184:187], v[60:63], v[228:231], v[184:187]
    v_mfma_f32_16x16x32_bf16 v[188:191], v[64:67], v[228:231], v[188:191]
    v_mfma_f32_16x16x32_bf16 v[192:195], v[68:71], v[228:231], v[192:195]
    v_mfma_f32_16x16x32_bf16 v[196:199], v[72:75], v[228:231], v[196:199]
    v_mfma_f32_16x16x32_bf16 v[180:183], v[76:79], v[232:235], v[180:183]
    v_mfma_f32_16x16x32_bf16 v[184:187], v[80:83], v[232:235], v[184:187]
    v_mfma_f32_16x16x32_bf16 v[188:191], v[84:87], v[232:235], v[188:191]
    v_mfma_f32_16x16x32_bf16 v[192:195], v[88:91], v[232:235], v[192:195]
    v_mfma_f32_16x16x32_bf16 v[196:199], v[92:95], v[232:235], v[196:199]
    v_mfma_f32_16x16x32_bf16 v[180:183], v[96:99], v[236:239], v[180:183]
    v_mfma_f32_16x16x32_bf16 v[184:187], v[100:103], v[236:239], v[184:187]
    v_mfma_f32_16x16x32_bf16 v[188:191], v[104:107], v[236:239], v[188:191]
    v_mfma_f32_16x16x32_bf16 v[192:195], v[108:111], v[236:239], v[192:195]
    v_mfma_f32_16x16x32_bf16 v[196:199], v[112:115], v[236:239], v[196:199]
    ds_write_b128 v9, v[160:163] offset:10240
    ds_write_b128 v9, v[164:167] offset:11264
    ds_write_b128 v9, v[168:171] offset:12288
    ds_write_b128 v9, v[172:175] offset:13312
    ds_write_b128 v9, v[176:179] offset:14336
    s_nop 7
    ds_write_b128 v9, v[180:183] offset:15360
    ds_write_b128 v9, v[184:187] offset:16384
    ds_write_b128 v9, v[188:191] offset:17408
    ds_write_b128 v9, v[192:195] offset:18432
    ds_write_b128 v9, v[196:199] offset:19456
    s_mul_i32 s50, s27, 17408
    s_add_u32 s50, s50, 81920
    v_add_u32 v7, s50, v2
    s_mul_i32 s50, s27, 5120
    v_add_u32 v9, s50, v2
    s_add_u32 s50, s45, s27
    s_mul_i32 s50, s50, 20480
    s_mul_i32 s51, s46, 32
    s_add_u32 s50, s50, s51
    v_mul_u32_u24 v8, 1280, v4
    v_lshl_add_u32 v8, v5, 3, v8
    s_waitcnt lgkmcnt(0)
    s_barrier
    v_add_u32 v10, 40960, v9
    ds_read_b128 v[96:99], v7 offset:3072
    ds_read_b128 v[100:103], v7 offset:4096
    ds_read_b128 v[104:107], v7 offset:8192
    ds_read_b128 v[108:111], v7 offset:9216
    ds_read_b128 v[112:115], v7 offset:13312
    ds_read_b128 v[116:119], v7 offset:14336
    ds_read_b128 v[120:123], v7 offset:15360
    ds_read_b128 v[124:127], v7 offset:16384
    ds_read_b128 v[128:131], v9 offset:3072
    ds_read_b128 v[132:135], v9 offset:4096
    ds_read_b128 v[136:139], v9 offset:23552
    ds_read_b128 v[140:143], v9 offset:24576
    ds_read_b128 v[144:147], v10 offset:3072
    ds_read_b128 v[148:151], v10 offset:4096
    ds_read_b128 v[152:155], v10 offset:23552
    ds_read_b128 v[156:159], v10 offset:24576
    s_waitcnt lgkmcnt(14)
    v_mov_b32 v192, v96
    v_mov_b32 v193, v97
    v_mov_b32 v194, v98
    v_mov_b32 v195, v99
    v_mov_b32 v196, v100
    v_mov_b32 v197, v101
    v_mov_b32 v198, v102
    v_mov_b32 v199, v103
    s_waitcnt lgkmcnt(12)
    v_pk_add_f32 v[192:193], v[192:193], v[104:105]
    v_pk_add_f32 v[194:195], v[194:195], v[106:107]
    v_pk_add_f32 v[196:197], v[196:197], v[108:109]
    v_pk_add_f32 v[198:199], v[198:199], v[110:111]
    s_waitcnt lgkmcnt(10)
    v_pk_add_f32 v[192:193], v[192:193], v[112:113]
    v_pk_add_f32 v[194:195], v[194:195], v[114:115]
    v_pk_add_f32 v[196:197], v[196:197], v[116:117]
    v_pk_add_f32 v[198:199], v[198:199], v[118:119]
    s_waitcnt lgkmcnt(8)
    v_pk_add_f32 v[192:193], v[192:193], v[120:121]
    v_pk_add_f32 v[194:195], v[194:195], v[122:123]
    v_pk_add_f32 v[196:197], v[196:197], v[124:125]
    v_pk_add_f32 v[198:199], v[198:199], v[126:127]
    s_waitcnt lgkmcnt(6)
    v_pk_add_f32 v[192:193], v[192:193], v[128:129]
    v_pk_add_f32 v[194:195], v[194:195], v[130:131]
    v_pk_add_f32 v[196:197], v[196:197], v[132:133]
    v_pk_add_f32 v[198:199], v[198:199], v[134:135]
    s_waitcnt lgkmcnt(4)
    v_pk_add_f32 v[192:193], v[192:193], v[136:137]
    v_pk_add_f32 v[194:195], v[194:195], v[138:139]
    v_pk_add_f32 v[196:197], v[196:197], v[140:141]
    v_pk_add_f32 v[198:199], v[198:199], v[142:143]
    s_waitcnt lgkmcnt(2)
    v_pk_add_f32 v[192:193], v[192:193], v[144:145]
    v_pk_add_f32 v[194:195], v[194:195], v[146:147]
    v_pk_add_f32 v[196:197], v[196:197], v[148:149]
    v_pk_add_f32 v[198:199], v[198:199], v[150:151]
    s_waitcnt lgkmcnt(0)
    v_pk_add_f32 v[192:193], v[192:193], v[152:153]
    v_pk_add_f32 v[194:195], v[194:195], v[154:155]
    v_pk_add_f32 v[196:197], v[196:197], v[156:157]
    v_pk_add_f32 v[198:199], v[198:199], v[158:159]
    v_cvt_pk_bf16_f32 v192, v192, v193
    v_cvt_pk_bf16_f32 v193, v194, v195
    buffer_store_dwordx2 v[192:193], v8, s[28:31], s50 offen offset:96
    v_cvt_pk_bf16_f32 v196, v196, v197
    v_cvt_pk_bf16_f32 v197, v198, v199
    buffer_store_dwordx2 v[196:197], v8, s[28:31], s50 offen offset:128
K2_END:
    s_endpgm
.section .rodata,"a"
.p2align 6
.amdhsa_kernel k1_kernel
  .amdhsa_next_free_vgpr 256
  .amdhsa_next_free_sgpr 96
  .amdhsa_accum_offset 256
  .amdhsa_group_segment_fixed_size 0
  .amdhsa_kernarg_size 88
  .amdhsa_user_sgpr_count 2
  .amdhsa_user_sgpr_kernarg_segment_ptr 1
  .amdhsa_system_sgpr_workgroup_id_x 1
.end_amdhsa_kernel
.p2align 6
.amdhsa_kernel k2_kernel
  .amdhsa_next_free_vgpr 256
  .amdhsa_next_free_sgpr 96
  .amdhsa_accum_offset 256
  .amdhsa_group_segment_fixed_size 0
  .amdhsa_kernarg_size 88
  .amdhsa_user_sgpr_count 2
  .amdhsa_user_sgpr_kernarg_segment_ptr 1
  .amdhsa_system_sgpr_workgroup_id_x 1
.end_amdhsa_kernel
```
